```python
import torch

def _softmax(x, axis=-1):
    return torch.softmax(x, dim=axis)
def _gelu(x):
    return torch.nn.functional.gelu(x, approximate="tanh")
def _silu(x):
    return torch.nn.functional.silu(x)
def _sigmoid(x):
    return torch.sigmoid(x)
def _layernorm(x, axis=-1, eps=1e-5):
    m = x.mean(dim=axis, keepdim=True)
    v = x.var(dim=axis, keepdim=True, unbiased=False)
    return (x - m) / torch.sqrt(v + eps)
def _scatter_add(tgt, idx, src, axis=0):
    return tgt.clone().index_add_(axis, idx, src)
def _segment_sum(src, seg, n):
    out = torch.zeros((n,) + src.shape[1:], dtype=src.dtype)
    return out.index_add_(0, seg, src)
def _pad(x, pw):
    flat = tuple(v for pair in reversed(pw) for v in pair)
    return torch.nn.functional.pad(x, flat)

kernel_name = 'gated_mix__sliding_block_cached__dense_activation_silu__decode'

def setup_inputs():

    _w = (lambda a: (lambda t: t.to(torch.bfloat16) if t.is_floating_point() else t)(torch.as_tensor(a)))
    def _A_setup():
        B, Sq, D = 2, 1, 640
        Hq, Hkv, Sk, Dh = 32, 32, 8192, 128
        assert Hq % Hkv == 0, (Hq, Hkv)
        return {
            "x": _w((lambda *s: torch.randn(*s, dtype=torch.bfloat16) * 0.05)(B, Sq, D)),
            "k_cache": _w((lambda *s: torch.randn(*s, dtype=torch.bfloat16) * 6.4)(B, Hkv, Sk, Dh)),
            "v_cache": _w((lambda *s: torch.randn(*s, dtype=torch.bfloat16) * 0.1)(B, Hkv, Sk, Dh)),
            "wq": _w((lambda *s: torch.randn(*s, dtype=torch.bfloat16) * 6.4)(D, Hq * Dh) * (D ** -0.5)),
            "wo": _w((lambda *s: torch.randn(*s, dtype=torch.bfloat16) * 0.1)(Hq * Dh, D) * ((Hq * Dh) ** -0.5)),
        }
    _A_in = _A_setup()

    def _B_setup():
        B, S, D, F = 2, 1, 640, 1728
        return {
            "x": _w((lambda *s: torch.randn(*s, dtype=torch.bfloat16) * 0.05)(B, S, D)),
            "w1": _w((lambda *s: torch.randn(*s, dtype=torch.bfloat16) * 3.2)(D, F) * (D ** -0.5)),
            "w2": _w((lambda *s: torch.randn(*s, dtype=torch.bfloat16) * 0.05)(F, D) * (F ** -0.5)),
        }
    _B_in = _B_setup()

    return {
        "A_x": _A_in["x"],
        "A_k_cache": _A_in["k_cache"],
        "A_v_cache": _A_in["v_cache"],
        "A_wq": _A_in["wq"],
        "A_wo": _A_in["wo"],
        "B_x": _B_in["x"],
        "B_w1": _B_in["w1"],
        "B_w2": _B_in["w2"],
        "gate_w": _w((lambda *s: torch.randn(*s, dtype=torch.bfloat16) * 0.05)(640) * 16.0),
    }

def reference(A_x, A_k_cache, A_v_cache, A_wq, A_wo, B_x, B_w1, B_w2, gate_w):
    def _A_ref(x, k_cache, v_cache, wq, wo):
        B, Sq, D = x.shape
        Hq, Dh = 32, 128
        Hkv, Sk = k_cache.shape[1], k_cache.shape[2]
        W = min(4096, max(256, Sk // 4))
        rep = Hq // Hkv
        q = (lambda x, *d: x.permute(*d))((x @ wq).reshape(B, Sq, Hq, Dh), 0, 2, 1, 3)
        k = (lambda x, n, axis: torch.repeat_interleave(x, n, dim=axis))(k_cache[:, :, Sk - W:, :], rep, axis=1)
        v = (lambda x, n, axis: torch.repeat_interleave(x, n, dim=axis))(v_cache[:, :, Sk - W:, :], rep, axis=1)
        scores = torch.einsum("bhqd,bhkd->bhqk", q, k) * (Dh ** -0.5)
        p = _softmax(scores, axis=-1)
        o = torch.einsum("bhqk,bhkd->bhqd", p, v)
        return (lambda x, *d: x.permute(*d))(o, 0, 2, 1, 3).reshape(B, Sq, Hq * Dh) @ wo

    def _B_ref(x, w1, w2):
        h = torch.einsum("bsd,df->bsf", x, w1)
        h = _silu(h)
        out = torch.einsum("bsf,fd->bsd", h, w2)
        return out

    x = A_x
    g = _sigmoid((x * gate_w).sum(-1, keepdims=True))
    a = _A_ref(x, A_k_cache, A_v_cache, A_wq, A_wo)
    b = _B_ref(x, B_w1, B_w2)
    return g * a + (1 - g) * b
```

```asm
; @launch grid=(256,1,1) block=(512,1,1) lds=53248
.amdgcn_target "amdgcn-amd-amdhsa--gfx950"
.text
.globl gated_mix__sliding_block_cached__dense_activation_silu__decode_kernel
.p2align 8
.type gated_mix__sliding_block_cached__dense_activation_silu__decode_kernel,@function
gated_mix__sliding_block_cached__dense_activation_silu__decode_kernel:
    s_cmp_ge_u32 s2, 256
    s_cbranch_scc1 L_end
    s_load_dwordx16 s[16:31], s[0:1], 0
    s_load_dwordx8 s[32:39], s[0:1], 64
    v_lshrrev_b32 v1, 6, v0
    v_and_b32 v0, 63, v0
    v_readfirstlane_b32 s3, v1
    s_and_b32 s4, s2, 7
    s_lshr_b32 s82, s2, 3
    s_and_b32 s83, s82, 3
    s_lshl_b32 s83, s83, 3
    s_or_b32 s4, s4, s83
    s_lshr_b32 s5, s2, 5
    s_cmp_ge_u32 s3, 4
    s_cbranch_scc0 L_A0
    s_lshr_b32 s6, s5, 2
    s_and_b32 s7, s5, 3
    s_lshr_b32 s82, s2, 3
    s_lshl_b32 s83, s3, 2
    s_add_u32 s83, s83, s82
    s_add_u32 s72, s83, 0
    s_and_b32 s72, s72, 31
    s_lshl_b32 s72, s72, 12
    s_add_u32 s73, s83, 1
    s_and_b32 s73, s73, 31
    s_lshl_b32 s73, s73, 12
    s_add_u32 s74, s83, 2
    s_and_b32 s74, s74, 31
    s_lshl_b32 s74, s74, 12
    s_add_u32 s75, s83, 3
    s_and_b32 s75, s75, 31
    s_lshl_b32 s75, s75, 12
    s_lshl_b32 s84, s6, 5
    s_add_u32 s84, s84, s4
    s_lshl_b32 s84, s84, 21
    s_lshl_b32 s85, s7, 17
    s_add_u32 s84, s84, s85
    s_add_u32 s84, s84, 1572864
    v_lshl_add_u32 v2, v0, 4, s84
    s_waitcnt lgkmcnt(0)
    s_mov_b32 s40, s18
    s_and_b32 s41, s19, 0xffff
    s_mov_b32 s42, 134217728
    s_mov_b32 s43, 0x20000
    buffer_load_dwordx4 v[16:19], v2, s[40:43], s72 offen offset:0 nt
    buffer_load_dwordx4 v[20:23], v2, s[40:43], s72 offen offset:1024 nt
    buffer_load_dwordx4 v[24:27], v2, s[40:43], s72 offen offset:2048 nt
    buffer_load_dwordx4 v[28:31], v2, s[40:43], s72 offen offset:3072 nt
    buffer_load_dwordx4 v[32:35], v2, s[40:43], s73 offen offset:0 nt
    buffer_load_dwordx4 v[36:39], v2, s[40:43], s73 offen offset:1024 nt
    buffer_load_dwordx4 v[40:43], v2, s[40:43], s73 offen offset:2048 nt
    buffer_load_dwordx4 v[44:47], v2, s[40:43], s73 offen offset:3072 nt
    buffer_load_dwordx4 v[48:51], v2, s[40:43], s74 offen offset:0 nt
    buffer_load_dwordx4 v[52:55], v2, s[40:43], s74 offen offset:1024 nt
    buffer_load_dwordx4 v[56:59], v2, s[40:43], s74 offen offset:2048 nt
    buffer_load_dwordx4 v[60:63], v2, s[40:43], s74 offen offset:3072 nt
    s_branch L_B0
L_A0:
    s_mul_i32 s87, s5, 80
    s_mul_i32 s88, s3, 20
    s_add_u32 s87, s87, s88
    s_lshl_b32 s89, s87, 13
    s_lshl_b32 s90, s4, 8
    s_add_u32 s89, s89, s90
    v_lshlrev_b32 v1, 2, v0
    s_waitcnt lgkmcnt(0)
    s_mov_b32 s48, s22
    s_and_b32 s49, s23, 0xffff
    s_mov_b32 s50, 5242880
    s_mov_b32 s51, 0x20000
    buffer_load_dword v80, v1, s[48:51], s89 offen
    s_add_u32 s89, s89, 8192
    buffer_load_dword v81, v1, s[48:51], s89 offen
    s_add_u32 s89, s89, 8192
    buffer_load_dword v82, v1, s[48:51], s89 offen
    s_add_u32 s89, s89, 8192
    buffer_load_dword v83, v1, s[48:51], s89 offen
    s_add_u32 s89, s89, 8192
    buffer_load_dword v84, v1, s[48:51], s89 offen
    s_add_u32 s89, s89, 8192
    buffer_load_dword v85, v1, s[48:51], s89 offen
    s_add_u32 s89, s89, 8192
    buffer_load_dword v86, v1, s[48:51], s89 offen
    s_add_u32 s89, s89, 8192
    buffer_load_dword v87, v1, s[48:51], s89 offen
    s_add_u32 s89, s89, 8192
    buffer_load_dword v88, v1, s[48:51], s89 offen
    s_add_u32 s89, s89, 8192
    buffer_load_dword v89, v1, s[48:51], s89 offen
    s_add_u32 s89, s89, 8192
    buffer_load_dword v90, v1, s[48:51], s89 offen
    s_add_u32 s89, s89, 8192
    buffer_load_dword v91, v1, s[48:51], s89 offen
    s_add_u32 s89, s89, 8192
    buffer_load_dword v92, v1, s[48:51], s89 offen
    s_add_u32 s89, s89, 8192
    buffer_load_dword v93, v1, s[48:51], s89 offen
    s_add_u32 s89, s89, 8192
    buffer_load_dword v94, v1, s[48:51], s89 offen
    s_add_u32 s89, s89, 8192
    buffer_load_dword v95, v1, s[48:51], s89 offen
    s_add_u32 s89, s89, 8192
    buffer_load_dword v96, v1, s[48:51], s89 offen
    s_add_u32 s89, s89, 8192
    buffer_load_dword v97, v1, s[48:51], s89 offen
    s_add_u32 s89, s89, 8192
    buffer_load_dword v98, v1, s[48:51], s89 offen
    s_add_u32 s89, s89, 8192
    buffer_load_dword v99, v1, s[48:51], s89 offen
    s_lshl_b32 s8, s4, 2
    s_and_b32 s7, s5, 3
    s_or_b32 s8, s8, s7
    s_lshr_b32 s6, s5, 2
    s_and_b32 s84, s2, 127
    s_cmp_lt_u32 s84, 40
    s_cselect_b32 s93, 1, 0
    s_cmp_lt_u32 s4, 27
    s_cselect_b32 s12, 2211840, 0
    s_cselect_b32 s13, 2211840, 0
    s_cselect_b32 s92, 0, 0x80000000
    s_mul_i32 s90, s87, 3456
    s_lshl_b32 s91, s4, 7
    s_add_u32 s90, s90, s91
    v_lshlrev_b32 v14, 1, v0
    s_mov_b32 s56, s28
    s_and_b32 s57, s29, 0xffff
    s_mov_b32 s58, s12
    s_mov_b32 s59, 0x20000
    buffer_load_ushort v100, v14, s[56:59], s90 offen
    buffer_load_ushort v101, v14, s[56:59], s90 offen offset:3456
    s_add_u32 s90, s90, 6912
    buffer_load_ushort v102, v14, s[56:59], s90 offen
    buffer_load_ushort v103, v14, s[56:59], s90 offen offset:3456
    s_add_u32 s90, s90, 6912
    buffer_load_ushort v104, v14, s[56:59], s90 offen
    buffer_load_ushort v105, v14, s[56:59], s90 offen offset:3456
    s_add_u32 s90, s90, 6912
    buffer_load_ushort v106, v14, s[56:59], s90 offen
    buffer_load_ushort v107, v14, s[56:59], s90 offen offset:3456
    s_add_u32 s90, s90, 6912
    buffer_load_ushort v108, v14, s[56:59], s90 offen
    buffer_load_ushort v109, v14, s[56:59], s90 offen offset:3456
    s_add_u32 s90, s90, 6912
    buffer_load_ushort v110, v14, s[56:59], s90 offen
    buffer_load_ushort v111, v14, s[56:59], s90 offen offset:3456
    s_add_u32 s90, s90, 6912
    buffer_load_ushort v112, v14, s[56:59], s90 offen
    buffer_load_ushort v113, v14, s[56:59], s90 offen offset:3456
    s_add_u32 s90, s90, 6912
    buffer_load_ushort v114, v14, s[56:59], s90 offen
    buffer_load_ushort v115, v14, s[56:59], s90 offen offset:3456
    s_add_u32 s90, s90, 6912
    buffer_load_ushort v116, v14, s[56:59], s90 offen
    buffer_load_ushort v117, v14, s[56:59], s90 offen offset:3456
    s_add_u32 s90, s90, 6912
    buffer_load_ushort v118, v14, s[56:59], s90 offen
    buffer_load_ushort v119, v14, s[56:59], s90 offen offset:3456
    s_lshl_b32 s14, s87, 1
    s_lshl_b32 s82, s3, 2
    v_mov_b32 v8, s82
    v_mov_b32 v9, 0
    ds_write_b32 v8, v9 offset:11632
    s_waitcnt lgkmcnt(0)
    s_barrier
    s_mov_b32 s40, s18
    s_and_b32 s41, s19, 0xffff
    s_mov_b32 s42, 134217728
    s_mov_b32 s43, 0x20000
    s_mov_b32 s44, s20
    s_and_b32 s45, s21, 0xffff
    s_mov_b32 s46, 134217728
    s_mov_b32 s47, 0x20000
    s_mov_b32 s52, s24
    s_and_b32 s53, s25, 0xffff
    s_mov_b32 s54, 5242880
    s_mov_b32 s55, 0x20000
    s_mov_b32 s60, s30
    s_and_b32 s61, s31, 0xffff
    s_mov_b32 s62, s13
    s_mov_b32 s63, 0x20000
    s_mov_b32 s64, s38
    s_and_b32 s65, s39, 0xffff
    s_mov_b32 s66, 16777216
    s_mov_b32 s67, 0x20000
    s_mov_b32 s68, s34
    s_and_b32 s69, s35, 0xffff
    s_mov_b32 s70, 2560
    s_mov_b32 s71, 0x20000
    s_load_dword s9, s[38:39], 0
    s_mov_b64 s[12:13], s[16:17]
    s_load_dwordx8 s[16:23], s[12:13], s14
    s_load_dwordx2 s[24:25], s[12:13], s14 offset:32
    s_load_dwordx8 s[28:35], s[12:13], s14 offset:1280
    s_load_dwordx2 s[26:27], s[12:13], s14 offset:1312
    s_lshr_b32 s82, s2, 3
    s_lshl_b32 s83, s3, 2
    s_add_u32 s83, s83, s82
    s_add_u32 s72, s83, 0
    s_and_b32 s72, s72, 31
    s_lshl_b32 s72, s72, 12
    s_add_u32 s73, s83, 1
    s_and_b32 s73, s73, 31
    s_lshl_b32 s73, s73, 12
    s_add_u32 s74, s83, 2
    s_and_b32 s74, s74, 31
    s_lshl_b32 s74, s74, 12
    s_add_u32 s75, s83, 3
    s_and_b32 s75, s75, 31
    s_lshl_b32 s75, s75, 12
    s_lshl_b32 s84, s6, 5
    s_add_u32 s84, s84, s4
    s_lshl_b32 s84, s84, 21
    s_lshl_b32 s85, s7, 17
    s_add_u32 s84, s84, s85
    s_add_u32 s84, s84, 1572864
    v_lshl_add_u32 v2, v0, 4, s84
    s_mul_i32 s10, s3, 2560
    v_add_u32 v14, 0, v0
    v_mul_u32_u24 v15, 205, v14
    v_lshrrev_b32 v15, 11, v15
    v_mul_u32_u24 v9, 10, v15
    v_sub_u32 v14, v14, v9
    v_lshlrev_b32 v14, 4, v14
    v_mul_u32_u24 v15, 1280, v15
    v_add_u32 v9, v14, v15
    v_add_u32 v14, 64, v0
    v_mul_u32_u24 v15, 205, v14
    v_lshrrev_b32 v15, 11, v15
    v_mul_u32_u24 v10, 10, v15
    v_sub_u32 v14, v14, v10
    v_lshlrev_b32 v14, 4, v14
    v_mul_u32_u24 v15, 1280, v15
    v_add_u32 v10, v14, v15
    v_add_u32 v14, 128, v0
    v_mul_u32_u24 v15, 205, v14
    v_lshrrev_b32 v15, 11, v15
    v_mul_u32_u24 v11, 10, v15
    v_sub_u32 v14, v14, v11
    v_lshlrev_b32 v14, 4, v14
    v_mul_u32_u24 v15, 1280, v15
    v_add_u32 v11, v14, v15
    s_mul_i32 s36, s4, 163840
    s_mul_i32 s82, s3, 20480
    s_add_u32 s36, s36, s82
    s_mul_i32 s82, s5, 160
    s_add_u32 s36, s36, s82
    s_lshl_b32 s15, s3, 2
    v_add_u32 v14, 0, v0
    v_mul_u32_u24 v15, 205, v14
    v_lshrrev_b32 v15, 14, v15
    v_mul_u32_u24 v170, 80, v15
    v_sub_u32 v14, v14, v170
    v_lshl_add_u32 v170, v15, 1, s15
    v_and_b32 v170, 14, v170
    v_xor_b32 v14, v14, v170
    v_lshlrev_b32 v14, 4, v14
    v_mul_u32_u24 v15, 1280, v15
    v_add_u32 v170, v14, v15
    v_add_u32 v14, 64, v0
    v_mul_u32_u24 v15, 205, v14
    v_lshrrev_b32 v15, 14, v15
    v_mul_u32_u24 v171, 80, v15
    v_sub_u32 v14, v14, v171
    v_lshl_add_u32 v171, v15, 1, s15
    v_and_b32 v171, 14, v171
    v_xor_b32 v14, v14, v171
    v_lshlrev_b32 v14, 4, v14
    v_mul_u32_u24 v15, 1280, v15
    v_add_u32 v171, v14, v15
    v_add_u32 v14, 128, v0
    v_mul_u32_u24 v15, 205, v14
    v_lshrrev_b32 v15, 14, v15
    v_mul_u32_u24 v172, 80, v15
    v_sub_u32 v14, v14, v172
    v_lshl_add_u32 v172, v15, 1, s15
    v_and_b32 v172, 14, v172
    v_xor_b32 v14, v14, v172
    v_lshlrev_b32 v14, 4, v14
    v_mul_u32_u24 v15, 1280, v15
    v_add_u32 v172, v14, v15
    s_mul_i32 s37, s8, 20480
    s_add_u32 s37, s37, s10
    s_mov_b32 s80, 0x05040100
    s_mov_b32 s81, 0x07060302
    s_mov_b32 s76, 0x7060500
    s_mov_b32 s77, 0x7060501
    s_mov_b32 s78, 0x7060502
    s_mov_b32 s79, 0x7060503
    s_mov_b32 s98, 0x0c0c0400
    s_mov_b32 s99, 0x05040100
    s_mov_b32 s11, 0x3e0293ee
    v_lshrrev_b32 v14, 4, v0
    v_bfe_u32 v15, v0, 2, 2
    v_lshl_add_u32 v234, v14, 2, v15
    s_min_u32 s84, s3, 4
    s_lshl_b32 s84, s84, 5
    s_add_u32 s84, s84, 32768
    v_mul_u32_u24 v235, 160, v234
    v_and_b32 v236, 3, v0
    v_lshl_add_u32 v235, v236, 3, v235
    v_add_u32 v8, s84, v235
    v_mul_u32_u24 v234, 1280, v234
    v_and_b32 v235, 1, v14
    v_lshlrev_b32 v235, 3, v235
    v_lshl_add_u32 v235, v15, 1, v235
    v_and_b32 v236, 1, v0
    v_lshl_add_u32 v234, v236, 3, v234
    v_add_u32 v234, 12288, v234
    v_bfe_u32 v236, v0, 1, 1
    s_mul_i32 s84, s3, 10
    s_add_u32 s85, s84, 0
    v_add_u32 v237, s85, v236
    v_xor_b32 v237, v237, v235
    v_lshl_add_u32 v3, v237, 4, v234
    s_add_u32 s85, s84, 2
    v_add_u32 v237, s85, v236
    v_xor_b32 v237, v237, v235
    v_lshl_add_u32 v4, v237, 4, v234
    s_add_u32 s85, s84, 4
    v_add_u32 v237, s85, v236
    v_xor_b32 v237, v237, v235
    v_lshl_add_u32 v5, v237, 4, v234
    s_add_u32 s85, s84, 6
    v_add_u32 v237, s85, v236
    v_xor_b32 v237, v237, v235
    v_lshl_add_u32 v6, v237, 4, v234
    s_add_u32 s85, s84, 8
    v_add_u32 v237, s85, v236
    v_xor_b32 v237, v237, v235
    v_lshl_add_u32 v7, v237, 4, v234
    v_add_u32 v237, 10784, v1
    v_mov_b32 v236, 0
    ds_write_b32 v237, v236
    v_mov_b32 v120, 0
    v_mov_b32 v121, 0
    v_mov_b32 v122, 0
    v_mov_b32 v123, 0
    v_mov_b32 v124, 0
    v_mov_b32 v125, 0
    s_waitcnt vmcnt(0) lgkmcnt(0)
    s_add_u32 s9, s9, 0x01010101
    v_mov_b32 v13, s9
    s_lshl_b32 s82, s16, 16
    s_lshl_b32 s83, s28, 16
    v_lshlrev_b32 v14, 16, v80
    v_and_b32 v15, 0xffff0000, v80
    v_lshlrev_b32 v100, 16, v100
    v_fmac_f32 v120, s82, v14
    v_fmac_f32 v121, s82, v15
    v_fmac_f32 v122, s83, v14
    v_fmac_f32 v123, s83, v15
    v_fmac_f32 v124, s82, v100
    v_fmac_f32 v125, s83, v100
    s_and_b32 s82, s16, 0xffff0000
    s_and_b32 s83, s28, 0xffff0000
    v_lshlrev_b32 v14, 16, v81
    v_and_b32 v15, 0xffff0000, v81
    v_lshlrev_b32 v101, 16, v101
    v_fmac_f32 v120, s82, v14
    v_fmac_f32 v121, s82, v15
    v_fmac_f32 v122, s83, v14
    v_fmac_f32 v123, s83, v15
    v_fmac_f32 v124, s82, v101
    v_fmac_f32 v125, s83, v101
    s_lshl_b32 s82, s17, 16
    s_lshl_b32 s83, s29, 16
    v_lshlrev_b32 v14, 16, v82
    v_and_b32 v15, 0xffff0000, v82
    v_lshlrev_b32 v102, 16, v102
    v_fmac_f32 v120, s82, v14
    v_fmac_f32 v121, s82, v15
    v_fmac_f32 v122, s83, v14
    v_fmac_f32 v123, s83, v15
    v_fmac_f32 v124, s82, v102
    v_fmac_f32 v125, s83, v102
    s_and_b32 s82, s17, 0xffff0000
    s_and_b32 s83, s29, 0xffff0000
    v_lshlrev_b32 v14, 16, v83
    v_and_b32 v15, 0xffff0000, v83
    v_lshlrev_b32 v103, 16, v103
    v_fmac_f32 v120, s82, v14
    v_fmac_f32 v121, s82, v15
    v_fmac_f32 v122, s83, v14
    v_fmac_f32 v123, s83, v15
    v_fmac_f32 v124, s82, v103
    v_fmac_f32 v125, s83, v103
    s_lshl_b32 s82, s18, 16
    s_lshl_b32 s83, s30, 16
    v_lshlrev_b32 v14, 16, v84
    v_and_b32 v15, 0xffff0000, v84
    v_lshlrev_b32 v104, 16, v104
    v_fmac_f32 v120, s82, v14
    v_fmac_f32 v121, s82, v15
    v_fmac_f32 v122, s83, v14
    v_fmac_f32 v123, s83, v15
    v_fmac_f32 v124, s82, v104
    v_fmac_f32 v125, s83, v104
    s_and_b32 s82, s18, 0xffff0000
    s_and_b32 s83, s30, 0xffff0000
    v_lshlrev_b32 v14, 16, v85
    v_and_b32 v15, 0xffff0000, v85
    v_lshlrev_b32 v105, 16, v105
    v_fmac_f32 v120, s82, v14
    v_fmac_f32 v121, s82, v15
    v_fmac_f32 v122, s83, v14
    v_fmac_f32 v123, s83, v15
    v_fmac_f32 v124, s82, v105
    v_fmac_f32 v125, s83, v105
    s_lshl_b32 s82, s19, 16
    s_lshl_b32 s83, s31, 16
    v_lshlrev_b32 v14, 16, v86
    v_and_b32 v15, 0xffff0000, v86
    v_lshlrev_b32 v106, 16, v106
    v_fmac_f32 v120, s82, v14
    v_fmac_f32 v121, s82, v15
    v_fmac_f32 v122, s83, v14
    v_fmac_f32 v123, s83, v15
    v_fmac_f32 v124, s82, v106
    v_fmac_f32 v125, s83, v106
    s_and_b32 s82, s19, 0xffff0000
    s_and_b32 s83, s31, 0xffff0000
    v_lshlrev_b32 v14, 16, v87
    v_and_b32 v15, 0xffff0000, v87
    v_lshlrev_b32 v107, 16, v107
    v_fmac_f32 v120, s82, v14
    v_fmac_f32 v121, s82, v15
    v_fmac_f32 v122, s83, v14
    v_fmac_f32 v123, s83, v15
    v_fmac_f32 v124, s82, v107
    v_fmac_f32 v125, s83, v107
    s_lshl_b32 s82, s20, 16
    s_lshl_b32 s83, s32, 16
    v_lshlrev_b32 v14, 16, v88
    v_and_b32 v15, 0xffff0000, v88
    v_lshlrev_b32 v108, 16, v108
    v_fmac_f32 v120, s82, v14
    v_fmac_f32 v121, s82, v15
    v_fmac_f32 v122, s83, v14
    v_fmac_f32 v123, s83, v15
    v_fmac_f32 v124, s82, v108
    v_fmac_f32 v125, s83, v108
    s_and_b32 s82, s20, 0xffff0000
    s_and_b32 s83, s32, 0xffff0000
    v_lshlrev_b32 v14, 16, v89
    v_and_b32 v15, 0xffff0000, v89
    v_lshlrev_b32 v109, 16, v109
    v_fmac_f32 v120, s82, v14
    v_fmac_f32 v121, s82, v15
    v_fmac_f32 v122, s83, v14
    v_fmac_f32 v123, s83, v15
    v_fmac_f32 v124, s82, v109
    v_fmac_f32 v125, s83, v109
    s_lshl_b32 s82, s21, 16
    s_lshl_b32 s83, s33, 16
    v_lshlrev_b32 v14, 16, v90
    v_and_b32 v15, 0xffff0000, v90
    v_lshlrev_b32 v110, 16, v110
    v_fmac_f32 v120, s82, v14
    v_fmac_f32 v121, s82, v15
    v_fmac_f32 v122, s83, v14
    v_fmac_f32 v123, s83, v15
    v_fmac_f32 v124, s82, v110
    v_fmac_f32 v125, s83, v110
    s_and_b32 s82, s21, 0xffff0000
    s_and_b32 s83, s33, 0xffff0000
    v_lshlrev_b32 v14, 16, v91
    v_and_b32 v15, 0xffff0000, v91
    v_lshlrev_b32 v111, 16, v111
    v_fmac_f32 v120, s82, v14
    v_fmac_f32 v121, s82, v15
    v_fmac_f32 v122, s83, v14
    v_fmac_f32 v123, s83, v15
    v_fmac_f32 v124, s82, v111
    v_fmac_f32 v125, s83, v111
    s_lshl_b32 s82, s22, 16
    s_lshl_b32 s83, s34, 16
    v_lshlrev_b32 v14, 16, v92
    v_and_b32 v15, 0xffff0000, v92
    v_lshlrev_b32 v112, 16, v112
    v_fmac_f32 v120, s82, v14
    v_fmac_f32 v121, s82, v15
    v_fmac_f32 v122, s83, v14
    v_fmac_f32 v123, s83, v15
    v_fmac_f32 v124, s82, v112
    v_fmac_f32 v125, s83, v112
    s_and_b32 s82, s22, 0xffff0000
    s_and_b32 s83, s34, 0xffff0000
    v_lshlrev_b32 v14, 16, v93
    v_and_b32 v15, 0xffff0000, v93
    v_lshlrev_b32 v113, 16, v113
    v_fmac_f32 v120, s82, v14
    v_fmac_f32 v121, s82, v15
    v_fmac_f32 v122, s83, v14
    v_fmac_f32 v123, s83, v15
    v_fmac_f32 v124, s82, v113
    v_fmac_f32 v125, s83, v113
    s_lshl_b32 s82, s23, 16
    s_lshl_b32 s83, s35, 16
    v_lshlrev_b32 v14, 16, v94
    v_and_b32 v15, 0xffff0000, v94
    v_lshlrev_b32 v114, 16, v114
    v_fmac_f32 v120, s82, v14
    v_fmac_f32 v121, s82, v15
    v_fmac_f32 v122, s83, v14
    v_fmac_f32 v123, s83, v15
    v_fmac_f32 v124, s82, v114
    v_fmac_f32 v125, s83, v114
    s_and_b32 s82, s23, 0xffff0000
    s_and_b32 s83, s35, 0xffff0000
    v_lshlrev_b32 v14, 16, v95
    v_and_b32 v15, 0xffff0000, v95
    v_lshlrev_b32 v115, 16, v115
    v_fmac_f32 v120, s82, v14
    v_fmac_f32 v121, s82, v15
    v_fmac_f32 v122, s83, v14
    v_fmac_f32 v123, s83, v15
    v_fmac_f32 v124, s82, v115
    v_fmac_f32 v125, s83, v115
    s_lshl_b32 s82, s24, 16
    s_lshl_b32 s83, s26, 16
    v_lshlrev_b32 v14, 16, v96
    v_and_b32 v15, 0xffff0000, v96
    v_lshlrev_b32 v116, 16, v116
    v_fmac_f32 v120, s82, v14
    v_fmac_f32 v121, s82, v15
    v_fmac_f32 v122, s83, v14
    v_fmac_f32 v123, s83, v15
    v_fmac_f32 v124, s82, v116
    v_fmac_f32 v125, s83, v116
    s_and_b32 s82, s24, 0xffff0000
    s_and_b32 s83, s26, 0xffff0000
    v_lshlrev_b32 v14, 16, v97
    v_and_b32 v15, 0xffff0000, v97
    v_lshlrev_b32 v117, 16, v117
    v_fmac_f32 v120, s82, v14
    v_fmac_f32 v121, s82, v15
    v_fmac_f32 v122, s83, v14
    v_fmac_f32 v123, s83, v15
    v_fmac_f32 v124, s82, v117
    v_fmac_f32 v125, s83, v117
    s_lshl_b32 s82, s25, 16
    s_lshl_b32 s83, s27, 16
    v_lshlrev_b32 v14, 16, v98
    v_and_b32 v15, 0xffff0000, v98
    v_lshlrev_b32 v118, 16, v118
    v_fmac_f32 v120, s82, v14
    v_fmac_f32 v121, s82, v15
    v_fmac_f32 v122, s83, v14
    v_fmac_f32 v123, s83, v15
    v_fmac_f32 v124, s82, v118
    v_fmac_f32 v125, s83, v118
    s_and_b32 s82, s25, 0xffff0000
    s_and_b32 s83, s27, 0xffff0000
    v_lshlrev_b32 v14, 16, v99
    v_and_b32 v15, 0xffff0000, v99
    v_lshlrev_b32 v119, 16, v119
    v_fmac_f32 v120, s82, v14
    v_fmac_f32 v121, s82, v15
    v_fmac_f32 v122, s83, v14
    v_fmac_f32 v123, s83, v15
    v_fmac_f32 v124, s82, v119
    v_fmac_f32 v125, s83, v119
    s_mul_i32 s82, s3, 1536
    s_add_u32 s82, s82, 0
    v_lshl_add_u32 v14, v0, 3, s82
    v_add_u32 v15, s82, v1
    ds_write_b64 v14, v[120:121]
    ds_write_b64 v14, v[122:123] offset:768
    ds_write_b32 v15, v124 offset:512
    ds_write_b32 v15, v125 offset:1280
    s_lshl_b32 s82, s3, 2
    v_mov_b32 v14, s82
    s_waitcnt lgkmcnt(0)
    v_mov_b32 v15, 1
    ds_write_b32 v14, v13 offset:11648
    ds_write_b32 v14, v15 offset:11632
    s_cmp_ge_u32 s3, 2
    s_cbranch_scc1 L_nopub
    s_mov_b32 s94, 0
    v_mov_b32 v14, 0
L_aspin:
    ds_read_b128 v[120:123], v14 offset:11632
    s_add_u32 s94, s94, 1
    s_waitcnt lgkmcnt(0)
    v_and_b32 v120, v120, v121
    v_and_b32 v122, v122, v123
    v_and_b32 v120, v120, v122
    s_cmp_gt_u32 s94, 100000
    s_cbranch_scc1 L_aok
    v_cmp_ne_u32 vcc, 1, v120
    s_cbranch_vccnz L_aspin
L_aok:
    s_mul_i32 s82, s3, 768
    s_add_u32 s82, s82, 0
    v_lshl_add_u32 v14, v0, 4, s82
    ds_read_b128 v[80:83], v14 offset:0
    ds_read_b128 v[84:87], v14 offset:1536
    ds_read_b128 v[88:91], v14 offset:3072
    ds_read_b128 v[92:95], v14 offset:4608
    s_lshl_b32 s83, s4, 3
    s_add_u32 s83, s83, s5
    s_lshl_b32 s83, s83, 1
    s_add_u32 s83, s83, s3
    s_mul_i32 s83, s83, 768
    s_add_u32 s83, s83, 4096
    v_lshl_add_u32 v15, v0, 4, s83
    s_waitcnt lgkmcnt(0)
    v_add_f32 v80, v80, v88
    v_add_f32 v81, v81, v89
    v_add_f32 v82, v82, v90
    v_add_f32 v83, v83, v91
    v_add_f32 v84, v84, v92
    v_add_f32 v85, v85, v93
    v_add_f32 v86, v86, v94
    v_add_f32 v87, v87, v95
    v_add_f32 v80, v80, v84
    v_add_f32 v81, v81, v85
    v_add_f32 v82, v82, v86
    v_add_f32 v83, v83, v87
    v_perm_b32 v80, v80, v13, s76
    v_perm_b32 v81, v81, v13, s77
    v_perm_b32 v82, v82, v13, s78
    v_perm_b32 v83, v83, v13, s79
    s_mov_b32 exec_hi, 0xffff
    buffer_store_dwordx4 v[80:83], v15, s[64:67], 0 offen sc1
    s_mov_b32 exec_hi, -1
L_nopub:
    buffer_load_dwordx4 v[16:19], v2, s[40:43], s72 offen offset:0 nt
    s_add_u32 m0, s10, 32768
    s_nop 0
    buffer_load_dwordx4 v9, s[52:55], s36 offen lds
    buffer_load_dwordx4 v[20:23], v2, s[40:43], s72 offen offset:1024 nt
    s_add_u32 m0, s10, 33792
    s_nop 0
    buffer_load_dwordx4 v10, s[52:55], s36 offen lds
    buffer_load_dwordx4 v[24:27], v2, s[40:43], s72 offen offset:2048 nt
    s_add_u32 m0, s10, 34816
    s_mov_b32 exec_hi, 0
    buffer_load_dwordx4 v11, s[52:55], s36 offen lds
    s_mov_b32 exec_hi, -1
    buffer_load_dwordx4 v[28:31], v2, s[40:43], s72 offen offset:3072 nt
    s_add_u32 m0, s10, 12288
    s_nop 0
    buffer_load_dwordx4 v170, s[60:63], s37 offen lds
    buffer_load_dwordx4 v[32:35], v2, s[40:43], s73 offen offset:0 nt
    s_add_u32 m0, s10, 13312
    s_nop 0
    buffer_load_dwordx4 v171, s[60:63], s37 offen lds
    buffer_load_dwordx4 v[36:39], v2, s[40:43], s73 offen offset:1024 nt
    s_add_u32 m0, s10, 14336
    s_mov_b32 exec_hi, 0
    buffer_load_dwordx4 v172, s[60:63], s37 offen lds
    s_mov_b32 exec_hi, -1
    buffer_load_dwordx4 v[40:43], v2, s[40:43], s73 offen offset:2048 nt
    buffer_load_dwordx4 v[44:47], v2, s[40:43], s73 offen offset:3072 nt
    buffer_load_dwordx4 v[48:51], v2, s[40:43], s74 offen offset:0 nt
    buffer_load_dwordx4 v[52:55], v2, s[40:43], s74 offen offset:1024 nt
    buffer_load_dwordx4 v[56:59], v2, s[40:43], s74 offen offset:2048 nt
    buffer_load_dwordx4 v[60:63], v2, s[40:43], s74 offen offset:3072 nt
    buffer_load_dwordx4 v[64:67], v2, s[40:43], s75 offen offset:0 nt
    buffer_load_dwordx4 v[68:71], v2, s[40:43], s75 offen offset:1024 nt
    buffer_load_dwordx4 v[72:75], v2, s[40:43], s75 offen offset:2048 nt
    buffer_load_dwordx4 v[76:79], v2, s[40:43], s75 offen offset:3072 nt
    v_mov_b32 v212, 0
    v_mov_b32 v213, 0
    v_mov_b32 v218, 0
    s_lshl_b32 s82, s4, 4
    s_add_u32 s82, s82, s6
    s_mul_i32 s82, s82, 768
    s_add_u32 s82, s82, 4096
    v_lshrrev_b32 v14, 5, v0
    v_mul_u32_u24 v14, 1536, v14
    v_and_b32 v15, 31, v0
    v_lshl_add_u32 v14, v15, 4, v14
    v_add_u32 v212, s82, v14
    v_bfe_u32 v14, v0, 2, 3
    v_mul_u32_u24 v14, 1536, v14
    v_and_b32 v15, 3, v0
    v_lshl_add_u32 v14, v15, 4, v14
    s_lshl_b32 s83, s7, 6
    s_add_u32 s83, s83, s82
    s_add_u32 s83, s83, 512
    v_add_u32 v213, s83, v14
    s_mov_b32 s94, 0
    v_add_u32 v218, 6144, v212
    s_mov_b32 s91, 393216
    s_cmp_eq_u32 s3, 0
    s_cbranch_scc0 L_noq
    buffer_load_dwordx4 v[192:195], v212, s[64:67], 0 offen offset:0 sc1
    buffer_load_dwordx4 v[196:199], v212, s[64:67], 0 offen offset:3072 sc1
    buffer_load_dwordx4 v[200:203], v218, s[64:67], 0 offen offset:0 sc1
    buffer_load_dwordx4 v[204:207], v218, s[64:67], 0 offen offset:3072 sc1
    buffer_load_dwordx4 v[208:211], v213, s[64:67], 0 offen sc1
    s_waitcnt vmcnt(0)
    s_branch L_qchk
L_qpoll:
    s_and_b32 s90, s94, 1
    s_cmp_eq_u32 s90, 1
    s_cselect_b32 s90, 0, s91
    buffer_load_dwordx4 v[192:195], v212, s[64:67], s90 offen offset:0 sc1
    buffer_load_dwordx4 v[196:199], v212, s[64:67], s90 offen offset:3072 sc1
    buffer_load_dwordx4 v[200:203], v218, s[64:67], s90 offen offset:0 sc1
    buffer_load_dwordx4 v[204:207], v218, s[64:67], s90 offen offset:3072 sc1
    buffer_load_dwordx4 v[208:211], v213, s[64:67], s90 offen sc1
    s_waitcnt vmcnt(0)
L_qchk:
    v_perm_b32 v214, v193, v192, s98
    v_perm_b32 v215, v195, v194, s98
    v_perm_b32 v214, v215, v214, s99
    v_cmp_ne_u32 vcc, v214, v13
    v_perm_b32 v214, v197, v196, s98
    v_perm_b32 v215, v199, v198, s98
    v_perm_b32 v214, v215, v214, s99
    v_cmp_ne_u32 s[12:13], v214, v13
    s_nop 0
    s_or_b64 vcc, vcc, s[12:13]
    v_perm_b32 v214, v201, v200, s98
    v_perm_b32 v215, v203, v202, s98
    v_perm_b32 v214, v215, v214, s99
    v_cmp_ne_u32 s[12:13], v214, v13
    s_nop 0
    s_or_b64 vcc, vcc, s[12:13]
    v_perm_b32 v214, v205, v204, s98
    v_perm_b32 v215, v207, v206, s98
    v_perm_b32 v214, v215, v214, s99
    v_cmp_ne_u32 s[12:13], v214, v13
    s_nop 0
    s_or_b64 vcc, vcc, s[12:13]
    v_perm_b32 v214, v209, v208, s98
    v_perm_b32 v215, v211, v210, s98
    v_perm_b32 v214, v215, v214, s99
    v_cmp_ne_u32 s[12:13], v214, v13
    s_nop 0
    s_or_b64 vcc, vcc, s[12:13]
    s_nop 0
    s_cbranch_vccz L_qok
    s_add_u32 s94, s94, 1
    s_cmp_gt_u32 s94, 20000
    s_cbranch_scc1 L_qok
    s_sleep 2
    s_branch L_qpoll
L_qok:
    v_and_b32 v192, 0xffffff00, v192
    v_and_b32 v193, 0xffffff00, v193
    v_and_b32 v194, 0xffffff00, v194
    v_and_b32 v195, 0xffffff00, v195
    v_and_b32 v196, 0xffffff00, v196
    v_and_b32 v197, 0xffffff00, v197
    v_and_b32 v198, 0xffffff00, v198
    v_and_b32 v199, 0xffffff00, v199
    v_and_b32 v200, 0xffffff00, v200
    v_and_b32 v201, 0xffffff00, v201
    v_and_b32 v202, 0xffffff00, v202
    v_and_b32 v203, 0xffffff00, v203
    v_and_b32 v204, 0xffffff00, v204
    v_and_b32 v205, 0xffffff00, v205
    v_and_b32 v206, 0xffffff00, v206
    v_and_b32 v207, 0xffffff00, v207
    v_and_b32 v208, 0xffffff00, v208
    v_and_b32 v209, 0xffffff00, v209
    v_and_b32 v210, 0xffffff00, v210
    v_and_b32 v211, 0xffffff00, v211
    v_add_f32 v192, v192, v196
    v_add_f32 v193, v193, v197
    v_add_f32 v194, v194, v198
    v_add_f32 v195, v195, v199
    v_add_f32 v192, v192, v200
    v_add_f32 v193, v193, v201
    v_add_f32 v194, v194, v202
    v_add_f32 v195, v195, v203
    v_add_f32 v192, v192, v204
    v_add_f32 v193, v193, v205
    v_add_f32 v194, v194, v206
    v_add_f32 v195, v195, v207
    s_nop 1
    v_permlane32_swap_b32 v192, v194
    v_permlane32_swap_b32 v193, v195
    s_nop 0
    v_add_f32 v192, v192, v194
    v_add_f32 v193, v193, v195
    v_and_b32 v14, 31, v0
    v_lshrrev_b32 v15, 5, v0
    v_lshlrev_b32 v15, 2, v15
    v_lshl_add_u32 v14, v14, 3, v15
    v_cvt_pk_bf16_f32 v192, v192, v193
    ds_write_b32 v14, v192 offset:11264
    v_add_f32_dpp v208, v208, v208 row_ror:4 row_mask:0xf bank_mask:0xf
    v_add_f32_dpp v209, v209, v209 row_ror:4 row_mask:0xf bank_mask:0xf
    v_add_f32_dpp v210, v210, v210 row_ror:4 row_mask:0xf bank_mask:0xf
    v_add_f32_dpp v211, v211, v211 row_ror:4 row_mask:0xf bank_mask:0xf
    v_add_f32_dpp v208, v208, v208 row_ror:8 row_mask:0xf bank_mask:0xf
    v_add_f32_dpp v209, v209, v209 row_ror:8 row_mask:0xf bank_mask:0xf
    v_add_f32_dpp v210, v210, v210 row_ror:8 row_mask:0xf bank_mask:0xf
    v_add_f32_dpp v211, v211, v211 row_ror:8 row_mask:0xf bank_mask:0xf
    v_mov_b32 v214, v208
    v_mov_b32 v215, v209
    v_mov_b32 v216, v210
    v_mov_b32 v217, v211
    s_nop 0
    v_permlane16_swap_b32 v208, v214
    v_permlane16_swap_b32 v209, v215
    v_permlane16_swap_b32 v210, v216
    v_permlane16_swap_b32 v211, v217
    s_nop 0
    v_add_f32 v208, v208, v214
    v_add_f32 v209, v209, v215
    v_add_f32 v210, v210, v216
    v_add_f32 v211, v211, v217
    v_mul_f32 v214, 0xbfb8aa3b, v208
    v_mul_f32 v215, 0xbfb8aa3b, v209
    v_mul_f32 v216, 0xbfb8aa3b, v210
    v_mul_f32 v217, 0xbfb8aa3b, v211
    v_exp_f32 v214, v214
    v_exp_f32 v215, v215
    v_exp_f32 v216, v216
    v_exp_f32 v217, v217
    v_add_f32 v214, 1.0, v214
    v_add_f32 v215, 1.0, v215
    v_add_f32 v216, 1.0, v216
    v_add_f32 v217, 1.0, v217
    v_rcp_f32 v214, v214
    v_rcp_f32 v215, v215
    v_rcp_f32 v216, v216
    v_rcp_f32 v217, v217
    v_mul_f32 v208, v208, v214
    v_mul_f32 v209, v209, v215
    v_mul_f32 v210, v210, v216
    v_mul_f32 v211, v211, v217
    v_cvt_pk_bf16_f32 v208, v208, v209
    v_cvt_pk_bf16_f32 v209, v210, v211
    v_and_b32 v14, 3, v0
    v_lshlrev_b32 v14, 3, v14
    ds_write_b64 v14, v[208:209] offset:11520
L_noq:
    s_waitcnt vmcnt(10) lgkmcnt(0)
    s_barrier
    buffer_load_dwordx4 v[80:83], v2, s[44:47], s72 offen offset:0 nt
    buffer_load_dwordx4 v[84:87], v2, s[44:47], s72 offen offset:1024 nt
    buffer_load_dwordx4 v[88:91], v2, s[44:47], s72 offen offset:2048 nt
    buffer_load_dwordx4 v[92:95], v2, s[44:47], s72 offen offset:3072 nt
    buffer_load_dwordx4 v[96:99], v2, s[44:47], s73 offen offset:0 nt
    buffer_load_dwordx4 v[100:103], v2, s[44:47], s73 offen offset:1024 nt
    buffer_load_dwordx4 v[104:107], v2, s[44:47], s73 offen offset:2048 nt
    buffer_load_dwordx4 v[108:111], v2, s[44:47], s73 offen offset:3072 nt
    buffer_load_dwordx4 v[112:115], v2, s[44:47], s74 offen offset:0 nt
    buffer_load_dwordx4 v[116:119], v2, s[44:47], s74 offen offset:1024 nt
    buffer_load_dwordx4 v[120:123], v2, s[44:47], s74 offen offset:2048 nt
    buffer_load_dwordx4 v[124:127], v2, s[44:47], s74 offen offset:3072 nt
    buffer_load_dwordx4 v[128:131], v2, s[44:47], s75 offen offset:0 nt
    buffer_load_dwordx4 v[132:135], v2, s[44:47], s75 offen offset:1024 nt
    buffer_load_dwordx4 v[136:139], v2, s[44:47], s75 offen offset:2048 nt
    buffer_load_dwordx4 v[140:143], v2, s[44:47], s75 offen offset:3072 nt
    s_branch L_J2
L_B0:
    v_lshlrev_b32 v1, 2, v0
    s_lshl_b32 s8, s4, 2
    s_and_b32 s7, s5, 3
    s_or_b32 s8, s8, s7
    s_lshr_b32 s6, s5, 2
    s_and_b32 s84, s2, 127
    s_cmp_lt_u32 s84, 40
    s_cselect_b32 s93, 1, 0
    s_cmp_lt_u32 s4, 27
    s_cselect_b32 s12, 2211840, 0
    s_cselect_b32 s13, 2211840, 0
    s_cselect_b32 s92, 0, 0x80000000
    s_cmp_eq_u32 s3, 7
    s_cbranch_scc0 L_nogate_ld
    global_load_dword v192, v1, s[16:17] offset:0
    global_load_dword v193, v1, s[16:17] offset:256
    global_load_dword v194, v1, s[16:17] offset:512
    global_load_dword v195, v1, s[16:17] offset:768
    global_load_dword v196, v1, s[16:17] offset:1024
    global_load_dword v197, v1, s[16:17] offset:1280
    global_load_dword v198, v1, s[16:17] offset:1536
    global_load_dword v199, v1, s[16:17] offset:1792
    global_load_dword v200, v1, s[16:17] offset:2048
    global_load_dword v201, v1, s[16:17] offset:2304
    global_load_dword v202, v1, s[32:33] offset:0
    global_load_dword v203, v1, s[32:33] offset:256
    global_load_dword v204, v1, s[32:33] offset:512
    global_load_dword v205, v1, s[32:33] offset:768
    global_load_dword v206, v1, s[32:33] offset:1024
L_nogate_ld:
    s_barrier
    s_mov_b32 s44, s20
    s_and_b32 s45, s21, 0xffff
    s_mov_b32 s46, 134217728
    s_mov_b32 s47, 0x20000
    s_mov_b32 s52, s24
    s_and_b32 s53, s25, 0xffff
    s_mov_b32 s54, 5242880
    s_mov_b32 s55, 0x20000
    s_mov_b32 s60, s30
    s_and_b32 s61, s31, 0xffff
    s_mov_b32 s62, s13
    s_mov_b32 s63, 0x20000
    s_mov_b32 s64, s38
    s_and_b32 s65, s39, 0xffff
    s_mov_b32 s66, 16777216
    s_mov_b32 s67, 0x20000
    s_mov_b32 s68, s34
    s_and_b32 s69, s35, 0xffff
    s_mov_b32 s70, 2560
    s_mov_b32 s71, 0x20000
    s_mul_i32 s10, s3, 2560
    v_add_u32 v14, 0, v0
    v_mul_u32_u24 v15, 205, v14
    v_lshrrev_b32 v15, 11, v15
    v_mul_u32_u24 v9, 10, v15
    v_sub_u32 v14, v14, v9
    v_lshlrev_b32 v14, 4, v14
    v_mul_u32_u24 v15, 1280, v15
    v_add_u32 v9, v14, v15
    v_add_u32 v14, 64, v0
    v_mul_u32_u24 v15, 205, v14
    v_lshrrev_b32 v15, 11, v15
    v_mul_u32_u24 v10, 10, v15
    v_sub_u32 v14, v14, v10
    v_lshlrev_b32 v14, 4, v14
    v_mul_u32_u24 v15, 1280, v15
    v_add_u32 v10, v14, v15
    v_add_u32 v14, 128, v0
    v_mul_u32_u24 v15, 205, v14
    v_lshrrev_b32 v15, 11, v15
    v_mul_u32_u24 v11, 10, v15
    v_sub_u32 v14, v14, v11
    v_lshlrev_b32 v14, 4, v14
    v_mul_u32_u24 v15, 1280, v15
    v_add_u32 v11, v14, v15
    s_mul_i32 s36, s4, 163840
    s_mul_i32 s82, s3, 20480
    s_add_u32 s36, s36, s82
    s_mul_i32 s82, s5, 160
    s_add_u32 s36, s36, s82
    s_lshl_b32 s15, s3, 2
    v_add_u32 v14, 0, v0
    v_mul_u32_u24 v15, 205, v14
    v_lshrrev_b32 v15, 14, v15
    v_mul_u32_u24 v170, 80, v15
    v_sub_u32 v14, v14, v170
    v_lshl_add_u32 v170, v15, 1, s15
    v_and_b32 v170, 14, v170
    v_xor_b32 v14, v14, v170
    v_lshlrev_b32 v14, 4, v14
    v_mul_u32_u24 v15, 1280, v15
    v_add_u32 v170, v14, v15
    v_add_u32 v14, 64, v0
    v_mul_u32_u24 v15, 205, v14
    v_lshrrev_b32 v15, 14, v15
    v_mul_u32_u24 v171, 80, v15
    v_sub_u32 v14, v14, v171
    v_lshl_add_u32 v171, v15, 1, s15
    v_and_b32 v171, 14, v171
    v_xor_b32 v14, v14, v171
    v_lshlrev_b32 v14, 4, v14
    v_mul_u32_u24 v15, 1280, v15
    v_add_u32 v171, v14, v15
    v_add_u32 v14, 128, v0
    v_mul_u32_u24 v15, 205, v14
    v_lshrrev_b32 v15, 14, v15
    v_mul_u32_u24 v172, 80, v15
    v_sub_u32 v14, v14, v172
    v_lshl_add_u32 v172, v15, 1, s15
    v_and_b32 v172, 14, v172
    v_xor_b32 v14, v14, v172
    v_lshlrev_b32 v14, 4, v14
    v_mul_u32_u24 v15, 1280, v15
    v_add_u32 v172, v14, v15
    s_mul_i32 s37, s8, 20480
    s_add_u32 s37, s37, s10
    s_mov_b32 s80, 0x05040100
    s_mov_b32 s81, 0x07060302
    s_mov_b32 s76, 0x7060500
    s_mov_b32 s77, 0x7060501
    s_mov_b32 s78, 0x7060502
    s_mov_b32 s79, 0x7060503
    s_mov_b32 s98, 0x0c0c0400
    s_mov_b32 s99, 0x05040100
    s_mov_b32 s11, 0x3e0293ee
    v_lshrrev_b32 v14, 4, v0
    v_bfe_u32 v15, v0, 2, 2
    v_lshl_add_u32 v234, v14, 2, v15
    s_min_u32 s84, s3, 4
    s_lshl_b32 s84, s84, 5
    s_add_u32 s84, s84, 32768
    v_mul_u32_u24 v235, 160, v234
    v_and_b32 v236, 3, v0
    v_lshl_add_u32 v235, v236, 3, v235
    v_add_u32 v8, s84, v235
    v_mul_u32_u24 v234, 1280, v234
    v_and_b32 v235, 1, v14
    v_lshlrev_b32 v235, 3, v235
    v_lshl_add_u32 v235, v15, 1, v235
    v_and_b32 v236, 1, v0
    v_lshl_add_u32 v234, v236, 3, v234
    v_add_u32 v234, 12288, v234
    v_bfe_u32 v236, v0, 1, 1
    s_mul_i32 s84, s3, 10
    s_add_u32 s85, s84, 0
    v_add_u32 v237, s85, v236
    v_xor_b32 v237, v237, v235
    v_lshl_add_u32 v3, v237, 4, v234
    s_add_u32 s85, s84, 2
    v_add_u32 v237, s85, v236
    v_xor_b32 v237, v237, v235
    v_lshl_add_u32 v4, v237, 4, v234
    s_add_u32 s85, s84, 4
    v_add_u32 v237, s85, v236
    v_xor_b32 v237, v237, v235
    v_lshl_add_u32 v5, v237, 4, v234
    s_add_u32 s85, s84, 6
    v_add_u32 v237, s85, v236
    v_xor_b32 v237, v237, v235
    v_lshl_add_u32 v6, v237, 4, v234
    s_add_u32 s85, s84, 8
    v_add_u32 v237, s85, v236
    v_xor_b32 v237, v237, v235
    v_lshl_add_u32 v7, v237, 4, v234
    v_add_u32 v237, 10784, v1
    v_mov_b32 v236, 0
    ds_write_b32 v237, v236
    buffer_load_dwordx4 v[64:67], v2, s[40:43], s75 offen offset:0 nt
    s_add_u32 m0, s10, 32768
    s_nop 0
    buffer_load_dwordx4 v9, s[52:55], s36 offen lds
    buffer_load_dwordx4 v[68:71], v2, s[40:43], s75 offen offset:1024 nt
    s_add_u32 m0, s10, 33792
    s_nop 0
    buffer_load_dwordx4 v10, s[52:55], s36 offen lds
    buffer_load_dwordx4 v[72:75], v2, s[40:43], s75 offen offset:2048 nt
    s_add_u32 m0, s10, 34816
    s_mov_b32 exec_hi, 0
    buffer_load_dwordx4 v11, s[52:55], s36 offen lds
    s_mov_b32 exec_hi, -1
    buffer_load_dwordx4 v[76:79], v2, s[40:43], s75 offen offset:3072 nt
    s_add_u32 m0, s10, 12288
    s_nop 0
    buffer_load_dwordx4 v170, s[60:63], s37 offen lds
    buffer_load_dwordx4 v[80:83], v2, s[44:47], s72 offen offset:0 nt
    s_add_u32 m0, s10, 13312
    s_nop 0
    buffer_load_dwordx4 v171, s[60:63], s37 offen lds
    buffer_load_dwordx4 v[84:87], v2, s[44:47], s72 offen offset:1024 nt
    s_add_u32 m0, s10, 14336
    s_mov_b32 exec_hi, 0
    buffer_load_dwordx4 v172, s[60:63], s37 offen lds
    s_mov_b32 exec_hi, -1
    buffer_load_dwordx4 v[88:91], v2, s[44:47], s72 offen offset:2048 nt
    buffer_load_dwordx4 v[92:95], v2, s[44:47], s72 offen offset:3072 nt
    buffer_load_dwordx4 v[96:99], v2, s[44:47], s73 offen offset:0 nt
    buffer_load_dwordx4 v[100:103], v2, s[44:47], s73 offen offset:1024 nt
    buffer_load_dwordx4 v[104:107], v2, s[44:47], s73 offen offset:2048 nt
    buffer_load_dwordx4 v[108:111], v2, s[44:47], s73 offen offset:3072 nt
    buffer_load_dwordx4 v[112:115], v2, s[44:47], s74 offen offset:0 nt
    buffer_load_dwordx4 v[116:119], v2, s[44:47], s74 offen offset:1024 nt
    buffer_load_dwordx4 v[120:123], v2, s[44:47], s74 offen offset:2048 nt
    buffer_load_dwordx4 v[124:127], v2, s[44:47], s74 offen offset:3072 nt
    buffer_load_dwordx4 v[128:131], v2, s[44:47], s75 offen offset:0 nt
    buffer_load_dwordx4 v[132:135], v2, s[44:47], s75 offen offset:1024 nt
    buffer_load_dwordx4 v[136:139], v2, s[44:47], s75 offen offset:2048 nt
    buffer_load_dwordx4 v[140:143], v2, s[44:47], s75 offen offset:3072 nt
    s_cmp_eq_u32 s3, 7
    s_cbranch_scc0 L_nogate
    s_waitcnt vmcnt(26)
    v_dot2_f32_bf16 v14, v192, v202, 0
    v_dot2_f32_bf16 v14, v193, v203, v14
    v_dot2_f32_bf16 v14, v194, v204, v14
    v_dot2_f32_bf16 v14, v195, v205, v14
    v_dot2_f32_bf16 v14, v196, v206, v14
    v_dot2_f32_bf16 v234, v197, v202, 0
    v_dot2_f32_bf16 v234, v198, v203, v234
    v_dot2_f32_bf16 v234, v199, v204, v234
    v_dot2_f32_bf16 v234, v200, v205, v234
    v_dot2_f32_bf16 v234, v201, v206, v234
    s_nop 2
    v_add_f32_dpp v14, v14, v14 quad_perm:[1,0,3,2] row_mask:0xf bank_mask:0xf
    s_nop 1
    v_add_f32_dpp v14, v14, v14 quad_perm:[2,3,0,1] row_mask:0xf bank_mask:0xf
    s_nop 1
    v_add_f32_dpp v14, v14, v14 row_ror:4 row_mask:0xf bank_mask:0xf
    s_nop 1
    v_add_f32_dpp v14, v14, v14 row_ror:8 row_mask:0xf bank_mask:0xf
    s_nop 1
    v_mov_b32 v15, v14
    s_nop 1
    v_permlane16_swap_b32 v14, v15
    s_nop 0
    v_add_f32 v14, v14, v15
    v_mov_b32 v15, v14
    s_nop 1
    v_permlane32_swap_b32 v14, v15
    s_nop 0
    v_add_f32 v14, v14, v15
    v_add_f32_dpp v234, v234, v234 quad_perm:[1,0,3,2] row_mask:0xf bank_mask:0xf
    s_nop 1
    v_add_f32_dpp v234, v234, v234 quad_perm:[2,3,0,1] row_mask:0xf bank_mask:0xf
    s_nop 1
    v_add_f32_dpp v234, v234, v234 row_ror:4 row_mask:0xf bank_mask:0xf
    s_nop 1
    v_add_f32_dpp v234, v234, v234 row_ror:8 row_mask:0xf bank_mask:0xf
    s_nop 1
    v_mov_b32 v15, v234
    s_nop 1
    v_permlane16_swap_b32 v234, v15
    s_nop 0
    v_add_f32 v234, v234, v15
    v_mov_b32 v15, v234
    s_nop 1
    v_permlane32_swap_b32 v234, v15
    s_nop 0
    v_add_f32 v234, v234, v15
    v_mul_f32 v14, 0xbfb8aa3b, v14
    v_mul_f32 v234, 0xbfb8aa3b, v234
    v_exp_f32 v14, v14
    v_exp_f32 v234, v234
    s_nop 0
    v_add_f32 v14, 1.0, v14
    v_add_f32 v234, 1.0, v234
    v_rcp_f32 v14, v14
    v_rcp_f32 v234, v234
    v_mov_b32 v15, 11616
    s_nop 0
    ds_write_b32 v15, v14
    ds_write_b32 v15, v234 offset:4
L_nogate:
    s_waitcnt vmcnt(14) lgkmcnt(0)
    s_barrier
    v_mov_b32 v14, 0
    ds_read_b32 v13, v14 offset:11648
L_J2:
    ds_read_b64_tr_b16 v[144:145], v8 offset:0
    ds_read_b64_tr_b16 v[146:147], v8 offset:2560
    ds_read_b64_tr_b16 v[148:149], v8 offset:5120
    ds_read_b64_tr_b16 v[150:151], v8 offset:7680
    ds_read_b64_tr_b16 v[152:153], v8 offset:10240
    ds_read_b64_tr_b16 v[154:155], v8 offset:12800
    ds_read_b64_tr_b16 v[156:157], v8 offset:15360
    ds_read_b64_tr_b16 v[158:159], v8 offset:17920
    ds_read_b64_tr_b16 v[160:161], v3
    ds_read_b64_tr_b16 v[162:163], v4
    ds_read_b64_tr_b16 v[164:165], v5
    ds_read_b64_tr_b16 v[166:167], v6
    ds_read_b64_tr_b16 v[168:169], v7
    v_and_b32 v14, 15, v0
    v_lshlrev_b32 v14, 4, v14
    ds_read_b128 v[176:179], v14 offset:11264
    v_lshrrev_b32 v15, 4, v0
    v_lshlrev_b32 v15, 3, v15
    ds_read_b64 v[190:191], v15 offset:11520
    s_waitcnt lgkmcnt(0)
    s_cmp_ge_u32 s3, 4
    s_cbranch_scc1 L_B3
    s_waitcnt vmcnt(16)
    v_dot2_f32_bf16 v16, v16, v176, 0
    v_dot2_f32_bf16 v20, v20, v176, 0
    v_dot2_f32_bf16 v24, v24, v176, 0
    v_dot2_f32_bf16 v28, v28, v176, 0
    v_dot2_f32_bf16 v32, v32, v176, 0
    v_dot2_f32_bf16 v36, v36, v176, 0
    v_dot2_f32_bf16 v40, v40, v176, 0
    v_dot2_f32_bf16 v44, v44, v176, 0
    v_dot2_f32_bf16 v48, v48, v176, 0
    v_dot2_f32_bf16 v52, v52, v176, 0
    v_dot2_f32_bf16 v56, v56, v176, 0
    v_dot2_f32_bf16 v60, v60, v176, 0
    v_dot2_f32_bf16 v64, v64, v176, 0
    v_dot2_f32_bf16 v68, v68, v176, 0
    v_dot2_f32_bf16 v72, v72, v176, 0
    v_dot2_f32_bf16 v76, v76, v176, 0
    v_dot2_f32_bf16 v16, v17, v177, v16
    v_dot2_f32_bf16 v20, v21, v177, v20
    v_dot2_f32_bf16 v24, v25, v177, v24
    v_dot2_f32_bf16 v28, v29, v177, v28
    v_dot2_f32_bf16 v32, v33, v177, v32
    v_dot2_f32_bf16 v36, v37, v177, v36
    v_dot2_f32_bf16 v40, v41, v177, v40
    v_dot2_f32_bf16 v44, v45, v177, v44
    v_dot2_f32_bf16 v48, v49, v177, v48
    v_dot2_f32_bf16 v52, v53, v177, v52
    v_dot2_f32_bf16 v56, v57, v177, v56
    v_dot2_f32_bf16 v60, v61, v177, v60
    v_dot2_f32_bf16 v64, v65, v177, v64
    v_dot2_f32_bf16 v68, v69, v177, v68
    v_dot2_f32_bf16 v72, v73, v177, v72
    v_dot2_f32_bf16 v76, v77, v177, v76
    v_dot2_f32_bf16 v16, v18, v178, v16
    v_dot2_f32_bf16 v20, v22, v178, v20
    v_dot2_f32_bf16 v24, v26, v178, v24
    v_dot2_f32_bf16 v28, v30, v178, v28
    v_dot2_f32_bf16 v32, v34, v178, v32
    v_dot2_f32_bf16 v36, v38, v178, v36
    v_dot2_f32_bf16 v40, v42, v178, v40
    v_dot2_f32_bf16 v44, v46, v178, v44
    v_dot2_f32_bf16 v48, v50, v178, v48
    v_dot2_f32_bf16 v52, v54, v178, v52
    v_dot2_f32_bf16 v56, v58, v178, v56
    v_dot2_f32_bf16 v60, v62, v178, v60
    v_dot2_f32_bf16 v64, v66, v178, v64
    v_dot2_f32_bf16 v68, v70, v178, v68
    v_dot2_f32_bf16 v72, v74, v178, v72
    v_dot2_f32_bf16 v76, v78, v178, v76
    v_dot2_f32_bf16 v16, v19, v179, v16
    v_dot2_f32_bf16 v20, v23, v179, v20
    v_dot2_f32_bf16 v24, v27, v179, v24
    v_dot2_f32_bf16 v28, v31, v179, v28
    v_dot2_f32_bf16 v32, v35, v179, v32
    v_dot2_f32_bf16 v36, v39, v179, v36
    v_dot2_f32_bf16 v40, v43, v179, v40
    v_dot2_f32_bf16 v44, v47, v179, v44
    v_dot2_f32_bf16 v48, v51, v179, v48
    v_dot2_f32_bf16 v52, v55, v179, v52
    v_dot2_f32_bf16 v56, v59, v179, v56
    v_dot2_f32_bf16 v60, v63, v179, v60
    v_dot2_f32_bf16 v64, v67, v179, v64
    v_dot2_f32_bf16 v68, v71, v179, v68
    v_dot2_f32_bf16 v72, v75, v179, v72
    v_dot2_f32_bf16 v76, v79, v179, v76
    v_add_f32_dpp v16, v16, v16 row_ror:8 row_mask:0xf bank_mask:0x3
    v_add_f32_dpp v20, v20, v20 row_ror:8 row_mask:0xf bank_mask:0x3
    v_add_f32_dpp v24, v24, v24 row_ror:8 row_mask:0xf bank_mask:0x3
    v_add_f32_dpp v28, v28, v28 row_ror:8 row_mask:0xf bank_mask:0x3
    v_add_f32_dpp v32, v32, v32 row_ror:8 row_mask:0xf bank_mask:0x3
    v_add_f32_dpp v36, v36, v36 row_ror:8 row_mask:0xf bank_mask:0x3
    v_add_f32_dpp v40, v40, v40 row_ror:8 row_mask:0xf bank_mask:0x3
    v_add_f32_dpp v44, v44, v44 row_ror:8 row_mask:0xf bank_mask:0x3
    v_add_f32_dpp v16, v48, v48 row_ror:8 row_mask:0xf bank_mask:0xc
    v_add_f32_dpp v20, v52, v52 row_ror:8 row_mask:0xf bank_mask:0xc
    v_add_f32_dpp v24, v56, v56 row_ror:8 row_mask:0xf bank_mask:0xc
    v_add_f32_dpp v28, v60, v60 row_ror:8 row_mask:0xf bank_mask:0xc
    v_add_f32_dpp v32, v64, v64 row_ror:8 row_mask:0xf bank_mask:0xc
    v_add_f32_dpp v36, v68, v68 row_ror:8 row_mask:0xf bank_mask:0xc
    v_add_f32_dpp v40, v72, v72 row_ror:8 row_mask:0xf bank_mask:0xc
    v_add_f32_dpp v44, v76, v76 row_ror:8 row_mask:0xf bank_mask:0xc
    v_add_f32_dpp v16, v16, v16 row_half_mirror row_mask:0xf bank_mask:0x5
    v_add_f32_dpp v20, v20, v20 row_half_mirror row_mask:0xf bank_mask:0x5
    v_add_f32_dpp v24, v24, v24 row_half_mirror row_mask:0xf bank_mask:0x5
    v_add_f32_dpp v28, v28, v28 row_half_mirror row_mask:0xf bank_mask:0x5
    v_add_f32_dpp v16, v32, v32 row_half_mirror row_mask:0xf bank_mask:0xa
    v_add_f32_dpp v20, v36, v36 row_half_mirror row_mask:0xf bank_mask:0xa
    v_add_f32_dpp v24, v40, v40 row_half_mirror row_mask:0xf bank_mask:0xa
    v_add_f32_dpp v28, v44, v44 row_half_mirror row_mask:0xf bank_mask:0xa
    v_add_f32_dpp v16, v16, v16 quad_perm:[1,0,3,2] row_mask:0xf bank_mask:0xf
    v_add_f32_dpp v20, v20, v20 quad_perm:[1,0,3,2] row_mask:0xf bank_mask:0xf
    v_add_f32_dpp v24, v24, v24 quad_perm:[1,0,3,2] row_mask:0xf bank_mask:0xf
    v_add_f32_dpp v28, v28, v28 quad_perm:[1,0,3,2] row_mask:0xf bank_mask:0xf
    v_add_f32_dpp v16, v16, v16 quad_perm:[2,3,0,1] row_mask:0xf bank_mask:0xf
    v_add_f32_dpp v20, v20, v20 quad_perm:[2,3,0,1] row_mask:0xf bank_mask:0xf
    v_add_f32_dpp v24, v24, v24 quad_perm:[2,3,0,1] row_mask:0xf bank_mask:0xf
    v_add_f32_dpp v28, v28, v28 quad_perm:[2,3,0,1] row_mask:0xf bank_mask:0xf
    v_max3_f32 v14, v16, v20, v24
    v_max_f32 v14, v14, v28
    s_nop 1
    v_max_f32_dpp v14, v14, v14 row_ror:4 row_mask:0xf bank_mask:0xf
    s_nop 1
    v_max_f32_dpp v14, v14, v14 row_ror:8 row_mask:0xf bank_mask:0xf
    s_nop 1
    v_mov_b32 v15, v14
    s_nop 1
    v_permlane16_swap_b32 v14, v15
    s_nop 0
    v_max_f32 v14, v14, v15
    v_mov_b32 v15, v14
    s_nop 1
    v_permlane32_swap_b32 v14, v15
    s_nop 0
    v_max_f32 v14, v14, v15
    v_mul_f32 v17, s11, v14
    v_fma_f32 v16, v16, s11, -v17
    v_fma_f32 v20, v20, s11, -v17
    v_fma_f32 v24, v24, s11, -v17
    v_fma_f32 v28, v28, s11, -v17
    v_exp_f32 v16, v16
    v_exp_f32 v20, v20
    v_exp_f32 v24, v24
    v_exp_f32 v28, v28
    s_nop 0
    v_cvt_pk_bf16_f32 v188, v16, v20
    v_cvt_pk_bf16_f32 v189, v24, v28
    v_add_f32 v18, v16, v20
    v_add_f32 v14, v24, v28
    v_add_f32 v18, v18, v14
    s_nop 1
    v_add_f32_dpp v18, v18, v18 row_ror:4 row_mask:0xf bank_mask:0xf
    s_nop 1
    v_add_f32_dpp v18, v18, v18 row_ror:8 row_mask:0xf bank_mask:0xf
    s_nop 1
    v_mov_b32 v15, v18
    s_nop 1
    v_permlane16_swap_b32 v18, v15
    s_nop 0
    v_add_f32 v18, v18, v15
    v_mov_b32 v15, v18
    s_nop 1
    v_permlane32_swap_b32 v18, v15
    s_nop 0
    v_add_f32 v18, v18, v15
    s_lshl_b32 s82, s3, 2
    v_mov_b32 v14, s82
    ds_write_b32 v14, v17 offset:11552
    ds_write_b32 v14, v18 offset:11584
    v_mfma_f32_16x16x16_bf16 v[32:35], v[190:191], v[160:161], 0
    v_mfma_f32_16x16x16_bf16 v[36:39], v[190:191], v[162:163], 0
    v_mfma_f32_16x16x16_bf16 v[40:43], v[190:191], v[164:165], 0
    v_mfma_f32_16x16x16_bf16 v[44:47], v[190:191], v[166:167], 0
    v_mfma_f32_16x16x16_bf16 v[48:51], v[190:191], v[168:169], 0
    s_mul_i32 s82, s6, 40
    s_mul_i32 s83, s3, 5
    s_add_u32 s82, s82, s83
    s_lshl_b32 s82, s82, 7
    s_add_u32 s82, s82, s8
    s_lshl_b32 s82, s82, 6
    s_add_u32 s82, s82, s92
    v_lshrrev_b32 v14, 4, v0
    v_lshlrev_b32 v14, 13, v14
    v_bfe_u32 v15, v0, 2, 2
    v_lshlrev_b32 v15, 4, v15
    v_add3_u32 v60, v14, v15, s82
    s_add_u32 s82, s82, 32768
    v_add_u32 v61, s82, v15
    s_mov_b32 s84, 1249280
    v_mov_b32 v19, v32
    v_mov_b32_dpp v19, v36 quad_perm:[0,1,2,3] row_mask:0x2 bank_mask:0xf
    v_mov_b32_dpp v19, v40 quad_perm:[0,1,2,3] row_mask:0x4 bank_mask:0xf
    v_mov_b32_dpp v19, v44 quad_perm:[0,1,2,3] row_mask:0x8 bank_mask:0xf
    s_nop 1
    v_mov_b32_dpp v52, v19 quad_perm:[0,0,0,0] row_mask:0xf bank_mask:0xf
    v_mov_b32_dpp v53, v19 quad_perm:[1,1,1,1] row_mask:0xf bank_mask:0xf
    v_mov_b32_dpp v54, v19 quad_perm:[2,2,2,2] row_mask:0xf bank_mask:0xf
    v_mov_b32_dpp v55, v19 quad_perm:[3,3,3,3] row_mask:0xf bank_mask:0xf
    v_mov_b32_dpp v56, v48 quad_perm:[0,0,0,0] row_mask:0xf bank_mask:0xf
    v_mov_b32_dpp v57, v48 quad_perm:[1,1,1,1] row_mask:0xf bank_mask:0xf
    v_mov_b32_dpp v58, v48 quad_perm:[2,2,2,2] row_mask:0xf bank_mask:0xf
    v_mov_b32_dpp v59, v48 quad_perm:[3,3,3,3] row_mask:0xf bank_mask:0xf
    v_perm_b32 v52, v52, v13, s76
    v_perm_b32 v53, v53, v13, s77
    v_perm_b32 v54, v54, v13, s78
    v_perm_b32 v55, v55, v13, s79
    v_perm_b32 v56, v56, v13, s76
    v_perm_b32 v57, v57, v13, s77
    v_perm_b32 v58, v58, v13, s78
    v_perm_b32 v59, v59, v13, s79
    s_mov_b32 exec_lo, 0x11111111
    s_mov_b32 exec_hi, 0x11111111
    buffer_store_dwordx4 v[52:55], v60, s[64:67], s84 offen sc1
    s_mov_b32 exec_lo, 0x1111
    s_mov_b32 exec_hi, 0
    buffer_store_dwordx4 v[56:59], v61, s[64:67], s84 offen sc1
    s_mov_b64 exec, -1
    v_mov_b32 v180, 0
    v_mov_b32 v181, 0
    v_mov_b32 v182, 0
    v_mov_b32 v183, 0
    v_mov_b32 v184, 0
    v_mov_b32 v185, 0
    v_mov_b32 v186, 0
    v_mov_b32 v187, 0
    s_waitcnt vmcnt(16)
    v_perm_b32 v64, v84, v80, s80
    v_perm_b32 v65, v84, v80, s81
    v_perm_b32 v66, v85, v81, s80
    v_perm_b32 v67, v85, v81, s81
    v_perm_b32 v68, v86, v82, s80
    v_perm_b32 v69, v86, v82, s81
    v_perm_b32 v70, v87, v83, s80
    v_perm_b32 v71, v87, v83, s81
    v_dot2c_f32_bf16_dpp v180, v188, v64 row_newbcast:0 row_mask:0xf bank_mask:0xf
    v_dot2c_f32_bf16_dpp v181, v188, v65 row_newbcast:0 row_mask:0xf bank_mask:0xf
    v_dot2c_f32_bf16_dpp v182, v188, v66 row_newbcast:0 row_mask:0xf bank_mask:0xf
    v_dot2c_f32_bf16_dpp v183, v188, v67 row_newbcast:0 row_mask:0xf bank_mask:0xf
    v_dot2c_f32_bf16_dpp v184, v188, v68 row_newbcast:0 row_mask:0xf bank_mask:0xf
    v_dot2c_f32_bf16_dpp v185, v188, v69 row_newbcast:0 row_mask:0xf bank_mask:0xf
    v_dot2c_f32_bf16_dpp v186, v188, v70 row_newbcast:0 row_mask:0xf bank_mask:0xf
    v_dot2c_f32_bf16_dpp v187, v188, v71 row_newbcast:0 row_mask:0xf bank_mask:0xf
    s_waitcnt vmcnt(14)
    v_perm_b32 v64, v92, v88, s80
    v_perm_b32 v65, v92, v88, s81
    v_perm_b32 v66, v93, v89, s80
    v_perm_b32 v67, v93, v89, s81
    v_perm_b32 v68, v94, v90, s80
    v_perm_b32 v69, v94, v90, s81
    v_perm_b32 v70, v95, v91, s80
    v_perm_b32 v71, v95, v91, s81
    v_dot2c_f32_bf16_dpp v180, v189, v64 row_newbcast:0 row_mask:0xf bank_mask:0xf
    v_dot2c_f32_bf16_dpp v181, v189, v65 row_newbcast:0 row_mask:0xf bank_mask:0xf
    v_dot2c_f32_bf16_dpp v182, v189, v66 row_newbcast:0 row_mask:0xf bank_mask:0xf
    v_dot2c_f32_bf16_dpp v183, v189, v67 row_newbcast:0 row_mask:0xf bank_mask:0xf
    v_dot2c_f32_bf16_dpp v184, v189, v68 row_newbcast:0 row_mask:0xf bank_mask:0xf
    v_dot2c_f32_bf16_dpp v185, v189, v69 row_newbcast:0 row_mask:0xf bank_mask:0xf
    v_dot2c_f32_bf16_dpp v186, v189, v70 row_newbcast:0 row_mask:0xf bank_mask:0xf
    v_dot2c_f32_bf16_dpp v187, v189, v71 row_newbcast:0 row_mask:0xf bank_mask:0xf
    s_waitcnt vmcnt(12)
    v_perm_b32 v64, v100, v96, s80
    v_perm_b32 v65, v100, v96, s81
    v_perm_b32 v66, v101, v97, s80
    v_perm_b32 v67, v101, v97, s81
    v_perm_b32 v68, v102, v98, s80
    v_perm_b32 v69, v102, v98, s81
    v_perm_b32 v70, v103, v99, s80
    v_perm_b32 v71, v103, v99, s81
    v_dot2c_f32_bf16_dpp v180, v188, v64 row_newbcast:4 row_mask:0xf bank_mask:0xf
    v_dot2c_f32_bf16_dpp v181, v188, v65 row_newbcast:4 row_mask:0xf bank_mask:0xf
    v_dot2c_f32_bf16_dpp v182, v188, v66 row_newbcast:4 row_mask:0xf bank_mask:0xf
    v_dot2c_f32_bf16_dpp v183, v188, v67 row_newbcast:4 row_mask:0xf bank_mask:0xf
    v_dot2c_f32_bf16_dpp v184, v188, v68 row_newbcast:4 row_mask:0xf bank_mask:0xf
    v_dot2c_f32_bf16_dpp v185, v188, v69 row_newbcast:4 row_mask:0xf bank_mask:0xf
    v_dot2c_f32_bf16_dpp v186, v188, v70 row_newbcast:4 row_mask:0xf bank_mask:0xf
    v_dot2c_f32_bf16_dpp v187, v188, v71 row_newbcast:4 row_mask:0xf bank_mask:0xf
    s_waitcnt vmcnt(10)
    v_perm_b32 v64, v108, v104, s80
    v_perm_b32 v65, v108, v104, s81
    v_perm_b32 v66, v109, v105, s80
    v_perm_b32 v67, v109, v105, s81
    v_perm_b32 v68, v110, v106, s80
    v_perm_b32 v69, v110, v106, s81
    v_perm_b32 v70, v111, v107, s80
    v_perm_b32 v71, v111, v107, s81
    v_dot2c_f32_bf16_dpp v180, v189, v64 row_newbcast:4 row_mask:0xf bank_mask:0xf
    v_dot2c_f32_bf16_dpp v181, v189, v65 row_newbcast:4 row_mask:0xf bank_mask:0xf
    v_dot2c_f32_bf16_dpp v182, v189, v66 row_newbcast:4 row_mask:0xf bank_mask:0xf
    v_dot2c_f32_bf16_dpp v183, v189, v67 row_newbcast:4 row_mask:0xf bank_mask:0xf
    v_dot2c_f32_bf16_dpp v184, v189, v68 row_newbcast:4 row_mask:0xf bank_mask:0xf
    v_dot2c_f32_bf16_dpp v185, v189, v69 row_newbcast:4 row_mask:0xf bank_mask:0xf
    v_dot2c_f32_bf16_dpp v186, v189, v70 row_newbcast:4 row_mask:0xf bank_mask:0xf
    v_dot2c_f32_bf16_dpp v187, v189, v71 row_newbcast:4 row_mask:0xf bank_mask:0xf
    s_waitcnt vmcnt(8)
    v_perm_b32 v64, v116, v112, s80
    v_perm_b32 v65, v116, v112, s81
    v_perm_b32 v66, v117, v113, s80
    v_perm_b32 v67, v117, v113, s81
    v_perm_b32 v68, v118, v114, s80
    v_perm_b32 v69, v118, v114, s81
    v_perm_b32 v70, v119, v115, s80
    v_perm_b32 v71, v119, v115, s81
    v_dot2c_f32_bf16_dpp v180, v188, v64 row_newbcast:8 row_mask:0xf bank_mask:0xf
    v_dot2c_f32_bf16_dpp v181, v188, v65 row_newbcast:8 row_mask:0xf bank_mask:0xf
    v_dot2c_f32_bf16_dpp v182, v188, v66 row_newbcast:8 row_mask:0xf bank_mask:0xf
    v_dot2c_f32_bf16_dpp v183, v188, v67 row_newbcast:8 row_mask:0xf bank_mask:0xf
    v_dot2c_f32_bf16_dpp v184, v188, v68 row_newbcast:8 row_mask:0xf bank_mask:0xf
    v_dot2c_f32_bf16_dpp v185, v188, v69 row_newbcast:8 row_mask:0xf bank_mask:0xf
    v_dot2c_f32_bf16_dpp v186, v188, v70 row_newbcast:8 row_mask:0xf bank_mask:0xf
    v_dot2c_f32_bf16_dpp v187, v188, v71 row_newbcast:8 row_mask:0xf bank_mask:0xf
    s_waitcnt vmcnt(6)
    v_perm_b32 v64, v124, v120, s80
    v_perm_b32 v65, v124, v120, s81
    v_perm_b32 v66, v125, v121, s80
    v_perm_b32 v67, v125, v121, s81
    v_perm_b32 v68, v126, v122, s80
    v_perm_b32 v69, v126, v122, s81
    v_perm_b32 v70, v127, v123, s80
    v_perm_b32 v71, v127, v123, s81
    v_dot2c_f32_bf16_dpp v180, v189, v64 row_newbcast:8 row_mask:0xf bank_mask:0xf
    v_dot2c_f32_bf16_dpp v181, v189, v65 row_newbcast:8 row_mask:0xf bank_mask:0xf
    v_dot2c_f32_bf16_dpp v182, v189, v66 row_newbcast:8 row_mask:0xf bank_mask:0xf
    v_dot2c_f32_bf16_dpp v183, v189, v67 row_newbcast:8 row_mask:0xf bank_mask:0xf
    v_dot2c_f32_bf16_dpp v184, v189, v68 row_newbcast:8 row_mask:0xf bank_mask:0xf
    v_dot2c_f32_bf16_dpp v185, v189, v69 row_newbcast:8 row_mask:0xf bank_mask:0xf
    v_dot2c_f32_bf16_dpp v186, v189, v70 row_newbcast:8 row_mask:0xf bank_mask:0xf
    v_dot2c_f32_bf16_dpp v187, v189, v71 row_newbcast:8 row_mask:0xf bank_mask:0xf
    s_waitcnt vmcnt(4)
    v_perm_b32 v64, v132, v128, s80
    v_perm_b32 v65, v132, v128, s81
    v_perm_b32 v66, v133, v129, s80
    v_perm_b32 v67, v133, v129, s81
    v_perm_b32 v68, v134, v130, s80
    v_perm_b32 v69, v134, v130, s81
    v_perm_b32 v70, v135, v131, s80
    v_perm_b32 v71, v135, v131, s81
    v_dot2c_f32_bf16_dpp v180, v188, v64 row_newbcast:12 row_mask:0xf bank_mask:0xf
    v_dot2c_f32_bf16_dpp v181, v188, v65 row_newbcast:12 row_mask:0xf bank_mask:0xf
    v_dot2c_f32_bf16_dpp v182, v188, v66 row_newbcast:12 row_mask:0xf bank_mask:0xf
    v_dot2c_f32_bf16_dpp v183, v188, v67 row_newbcast:12 row_mask:0xf bank_mask:0xf
    v_dot2c_f32_bf16_dpp v184, v188, v68 row_newbcast:12 row_mask:0xf bank_mask:0xf
    v_dot2c_f32_bf16_dpp v185, v188, v69 row_newbcast:12 row_mask:0xf bank_mask:0xf
    v_dot2c_f32_bf16_dpp v186, v188, v70 row_newbcast:12 row_mask:0xf bank_mask:0xf
    v_dot2c_f32_bf16_dpp v187, v188, v71 row_newbcast:12 row_mask:0xf bank_mask:0xf
    s_waitcnt vmcnt(2)
    v_perm_b32 v64, v140, v136, s80
    v_perm_b32 v65, v140, v136, s81
    v_perm_b32 v66, v141, v137, s80
    v_perm_b32 v67, v141, v137, s81
    v_perm_b32 v68, v142, v138, s80
    v_perm_b32 v69, v142, v138, s81
    v_perm_b32 v70, v143, v139, s80
    v_perm_b32 v71, v143, v139, s81
    v_dot2c_f32_bf16_dpp v180, v189, v64 row_newbcast:12 row_mask:0xf bank_mask:0xf
    v_dot2c_f32_bf16_dpp v181, v189, v65 row_newbcast:12 row_mask:0xf bank_mask:0xf
    v_dot2c_f32_bf16_dpp v182, v189, v66 row_newbcast:12 row_mask:0xf bank_mask:0xf
    v_dot2c_f32_bf16_dpp v183, v189, v67 row_newbcast:12 row_mask:0xf bank_mask:0xf
    v_dot2c_f32_bf16_dpp v184, v189, v68 row_newbcast:12 row_mask:0xf bank_mask:0xf
    v_dot2c_f32_bf16_dpp v185, v189, v69 row_newbcast:12 row_mask:0xf bank_mask:0xf
    v_dot2c_f32_bf16_dpp v186, v189, v70 row_newbcast:12 row_mask:0xf bank_mask:0xf
    v_dot2c_f32_bf16_dpp v187, v189, v71 row_newbcast:12 row_mask:0xf bank_mask:0xf
    s_lshl_b32 s82, s3, 9
    v_and_b32 v14, 15, v0
    v_lshrrev_b32 v15, 4, v0
    v_permlane32_swap_b32 v180, v184
    v_permlane32_swap_b32 v181, v185
    v_permlane32_swap_b32 v182, v186
    v_permlane32_swap_b32 v183, v187
    v_lshlrev_b32 v15, 3, v15
    v_add_f32 v180, v180, v184
    v_add_f32 v181, v181, v185
    v_add_f32 v182, v182, v186
    v_add_f32 v183, v183, v187
    v_lshl_add_u32 v14, v14, 5, v15
    v_add_u32 v14, s82, v14
    v_permlane16_swap_b32 v180, v182
    v_permlane16_swap_b32 v181, v183
    s_nop 0
    v_add_f32 v180, v180, v182
    v_add_f32 v181, v181, v183
    ds_write_b64 v14, v[180:181] offset:6144
    s_branch L_J4
L_B3:
    s_waitcnt vmcnt(16)
    v_dot2_f32_bf16 v16, v16, v176, 0
    v_dot2_f32_bf16 v20, v20, v176, 0
    v_dot2_f32_bf16 v24, v24, v176, 0
    v_dot2_f32_bf16 v28, v28, v176, 0
    v_dot2_f32_bf16 v32, v32, v176, 0
    v_dot2_f32_bf16 v36, v36, v176, 0
    v_dot2_f32_bf16 v40, v40, v176, 0
    v_dot2_f32_bf16 v44, v44, v176, 0
    v_dot2_f32_bf16 v48, v48, v176, 0
    v_dot2_f32_bf16 v52, v52, v176, 0
    v_dot2_f32_bf16 v56, v56, v176, 0
    v_dot2_f32_bf16 v60, v60, v176, 0
    v_dot2_f32_bf16 v64, v64, v176, 0
    v_dot2_f32_bf16 v68, v68, v176, 0
    v_dot2_f32_bf16 v72, v72, v176, 0
    v_dot2_f32_bf16 v76, v76, v176, 0
    v_dot2_f32_bf16 v16, v17, v177, v16
    v_dot2_f32_bf16 v20, v21, v177, v20
    v_dot2_f32_bf16 v24, v25, v177, v24
    v_dot2_f32_bf16 v28, v29, v177, v28
    v_dot2_f32_bf16 v32, v33, v177, v32
    v_dot2_f32_bf16 v36, v37, v177, v36
    v_dot2_f32_bf16 v40, v41, v177, v40
    v_dot2_f32_bf16 v44, v45, v177, v44
    v_dot2_f32_bf16 v48, v49, v177, v48
    v_dot2_f32_bf16 v52, v53, v177, v52
    v_dot2_f32_bf16 v56, v57, v177, v56
    v_dot2_f32_bf16 v60, v61, v177, v60
    v_dot2_f32_bf16 v64, v65, v177, v64
    v_dot2_f32_bf16 v68, v69, v177, v68
    v_dot2_f32_bf16 v72, v73, v177, v72
    v_dot2_f32_bf16 v76, v77, v177, v76
    v_dot2_f32_bf16 v16, v18, v178, v16
    v_dot2_f32_bf16 v20, v22, v178, v20
    v_dot2_f32_bf16 v24, v26, v178, v24
    v_dot2_f32_bf16 v28, v30, v178, v28
    v_dot2_f32_bf16 v32, v34, v178, v32
    v_dot2_f32_bf16 v36, v38, v178, v36
    v_dot2_f32_bf16 v40, v42, v178, v40
    v_dot2_f32_bf16 v44, v46, v178, v44
    v_dot2_f32_bf16 v48, v50, v178, v48
    v_dot2_f32_bf16 v52, v54, v178, v52
    v_dot2_f32_bf16 v56, v58, v178, v56
    v_dot2_f32_bf16 v60, v62, v178, v60
    v_dot2_f32_bf16 v64, v66, v178, v64
    v_dot2_f32_bf16 v68, v70, v178, v68
    v_dot2_f32_bf16 v72, v74, v178, v72
    v_dot2_f32_bf16 v76, v78, v178, v76
    v_dot2_f32_bf16 v16, v19, v179, v16
    v_dot2_f32_bf16 v20, v23, v179, v20
    v_dot2_f32_bf16 v24, v27, v179, v24
    v_dot2_f32_bf16 v28, v31, v179, v28
    v_dot2_f32_bf16 v32, v35, v179, v32
    v_dot2_f32_bf16 v36, v39, v179, v36
    v_dot2_f32_bf16 v40, v43, v179, v40
    v_dot2_f32_bf16 v44, v47, v179, v44
    v_dot2_f32_bf16 v48, v51, v179, v48
    v_dot2_f32_bf16 v52, v55, v179, v52
    v_dot2_f32_bf16 v56, v59, v179, v56
    v_dot2_f32_bf16 v60, v63, v179, v60
    v_dot2_f32_bf16 v64, v67, v179, v64
    v_dot2_f32_bf16 v68, v71, v179, v68
    v_dot2_f32_bf16 v72, v75, v179, v72
    v_dot2_f32_bf16 v76, v79, v179, v76
    v_add_f32_dpp v16, v16, v16 row_ror:8 row_mask:0xf bank_mask:0x3
    v_add_f32_dpp v20, v20, v20 row_ror:8 row_mask:0xf bank_mask:0x3
    v_add_f32_dpp v24, v24, v24 row_ror:8 row_mask:0xf bank_mask:0x3
    v_add_f32_dpp v28, v28, v28 row_ror:8 row_mask:0xf bank_mask:0x3
    v_add_f32_dpp v32, v32, v32 row_ror:8 row_mask:0xf bank_mask:0x3
    v_add_f32_dpp v36, v36, v36 row_ror:8 row_mask:0xf bank_mask:0x3
    v_add_f32_dpp v40, v40, v40 row_ror:8 row_mask:0xf bank_mask:0x3
    v_add_f32_dpp v44, v44, v44 row_ror:8 row_mask:0xf bank_mask:0x3
    v_add_f32_dpp v16, v48, v48 row_ror:8 row_mask:0xf bank_mask:0xc
    v_add_f32_dpp v20, v52, v52 row_ror:8 row_mask:0xf bank_mask:0xc
    v_add_f32_dpp v24, v56, v56 row_ror:8 row_mask:0xf bank_mask:0xc
    v_add_f32_dpp v28, v60, v60 row_ror:8 row_mask:0xf bank_mask:0xc
    v_add_f32_dpp v32, v64, v64 row_ror:8 row_mask:0xf bank_mask:0xc
    v_add_f32_dpp v36, v68, v68 row_ror:8 row_mask:0xf bank_mask:0xc
    v_add_f32_dpp v40, v72, v72 row_ror:8 row_mask:0xf bank_mask:0xc
    v_add_f32_dpp v44, v76, v76 row_ror:8 row_mask:0xf bank_mask:0xc
    v_add_f32_dpp v16, v16, v16 row_half_mirror row_mask:0xf bank_mask:0x5
    v_add_f32_dpp v20, v20, v20 row_half_mirror row_mask:0xf bank_mask:0x5
    v_add_f32_dpp v24, v24, v24 row_half_mirror row_mask:0xf bank_mask:0x5
    v_add_f32_dpp v28, v28, v28 row_half_mirror row_mask:0xf bank_mask:0x5
    v_add_f32_dpp v16, v32, v32 row_half_mirror row_mask:0xf bank_mask:0xa
    v_add_f32_dpp v20, v36, v36 row_half_mirror row_mask:0xf bank_mask:0xa
    v_add_f32_dpp v24, v40, v40 row_half_mirror row_mask:0xf bank_mask:0xa
    v_add_f32_dpp v28, v44, v44 row_half_mirror row_mask:0xf bank_mask:0xa
    v_add_f32_dpp v16, v16, v16 quad_perm:[1,0,3,2] row_mask:0xf bank_mask:0xf
    v_add_f32_dpp v20, v20, v20 quad_perm:[1,0,3,2] row_mask:0xf bank_mask:0xf
    v_add_f32_dpp v24, v24, v24 quad_perm:[1,0,3,2] row_mask:0xf bank_mask:0xf
    v_add_f32_dpp v28, v28, v28 quad_perm:[1,0,3,2] row_mask:0xf bank_mask:0xf
    v_add_f32_dpp v16, v16, v16 quad_perm:[2,3,0,1] row_mask:0xf bank_mask:0xf
    v_add_f32_dpp v20, v20, v20 quad_perm:[2,3,0,1] row_mask:0xf bank_mask:0xf
    v_add_f32_dpp v24, v24, v24 quad_perm:[2,3,0,1] row_mask:0xf bank_mask:0xf
    v_add_f32_dpp v28, v28, v28 quad_perm:[2,3,0,1] row_mask:0xf bank_mask:0xf
    v_max3_f32 v14, v16, v20, v24
    v_max_f32 v14, v14, v28
    s_nop 1
    v_max_f32_dpp v14, v14, v14 row_ror:4 row_mask:0xf bank_mask:0xf
    s_nop 1
    v_max_f32_dpp v14, v14, v14 row_ror:8 row_mask:0xf bank_mask:0xf
    s_nop 1
    v_mov_b32 v15, v14
    s_nop 1
    v_permlane16_swap_b32 v14, v15
    s_nop 0
    v_max_f32 v14, v14, v15
    v_mov_b32 v15, v14
    s_nop 1
    v_permlane32_swap_b32 v14, v15
    s_nop 0
    v_max_f32 v14, v14, v15
    v_mul_f32 v17, s11, v14
    v_fma_f32 v16, v16, s11, -v17
    v_fma_f32 v20, v20, s11, -v17
    v_fma_f32 v24, v24, s11, -v17
    v_fma_f32 v28, v28, s11, -v17
    v_exp_f32 v16, v16
    v_exp_f32 v20, v20
    v_exp_f32 v24, v24
    v_exp_f32 v28, v28
    s_nop 0
    v_cvt_pk_bf16_f32 v188, v16, v20
    v_cvt_pk_bf16_f32 v189, v24, v28
    v_add_f32 v18, v16, v20
    v_add_f32 v14, v24, v28
    v_add_f32 v18, v18, v14
    s_nop 1
    v_add_f32_dpp v18, v18, v18 row_ror:4 row_mask:0xf bank_mask:0xf
    s_nop 1
    v_add_f32_dpp v18, v18, v18 row_ror:8 row_mask:0xf bank_mask:0xf
    s_nop 1
    v_mov_b32 v15, v18
    s_nop 1
    v_permlane16_swap_b32 v18, v15
    s_nop 0
    v_add_f32 v18, v18, v15
    v_mov_b32 v15, v18
    s_nop 1
    v_permlane32_swap_b32 v18, v15
    s_nop 0
    v_add_f32 v18, v18, v15
    s_lshl_b32 s82, s3, 2
    v_mov_b32 v14, s82
    ds_write_b32 v14, v17 offset:11552
    ds_write_b32 v14, v18 offset:11584
    v_mov_b32 v180, 0
    v_mov_b32 v181, 0
    v_mov_b32 v182, 0
    v_mov_b32 v183, 0
    v_mov_b32 v184, 0
    v_mov_b32 v185, 0
    v_mov_b32 v186, 0
    v_mov_b32 v187, 0
    s_waitcnt vmcnt(14)
    v_perm_b32 v64, v84, v80, s80
    v_perm_b32 v65, v84, v80, s81
    v_perm_b32 v66, v85, v81, s80
    v_perm_b32 v67, v85, v81, s81
    v_perm_b32 v68, v86, v82, s80
    v_perm_b32 v69, v86, v82, s81
    v_perm_b32 v70, v87, v83, s80
    v_perm_b32 v71, v87, v83, s81
    v_dot2c_f32_bf16_dpp v180, v188, v64 row_newbcast:0 row_mask:0xf bank_mask:0xf
    v_dot2c_f32_bf16_dpp v181, v188, v65 row_newbcast:0 row_mask:0xf bank_mask:0xf
    v_dot2c_f32_bf16_dpp v182, v188, v66 row_newbcast:0 row_mask:0xf bank_mask:0xf
    v_dot2c_f32_bf16_dpp v183, v188, v67 row_newbcast:0 row_mask:0xf bank_mask:0xf
    v_dot2c_f32_bf16_dpp v184, v188, v68 row_newbcast:0 row_mask:0xf bank_mask:0xf
    v_dot2c_f32_bf16_dpp v185, v188, v69 row_newbcast:0 row_mask:0xf bank_mask:0xf
    v_dot2c_f32_bf16_dpp v186, v188, v70 row_newbcast:0 row_mask:0xf bank_mask:0xf
    v_dot2c_f32_bf16_dpp v187, v188, v71 row_newbcast:0 row_mask:0xf bank_mask:0xf
    s_waitcnt vmcnt(12)
    v_perm_b32 v64, v92, v88, s80
    v_perm_b32 v65, v92, v88, s81
    v_perm_b32 v66, v93, v89, s80
    v_perm_b32 v67, v93, v89, s81
    v_perm_b32 v68, v94, v90, s80
    v_perm_b32 v69, v94, v90, s81
    v_perm_b32 v70, v95, v91, s80
    v_perm_b32 v71, v95, v91, s81
    v_dot2c_f32_bf16_dpp v180, v189, v64 row_newbcast:0 row_mask:0xf bank_mask:0xf
    v_dot2c_f32_bf16_dpp v181, v189, v65 row_newbcast:0 row_mask:0xf bank_mask:0xf
    v_dot2c_f32_bf16_dpp v182, v189, v66 row_newbcast:0 row_mask:0xf bank_mask:0xf
    v_dot2c_f32_bf16_dpp v183, v189, v67 row_newbcast:0 row_mask:0xf bank_mask:0xf
    v_dot2c_f32_bf16_dpp v184, v189, v68 row_newbcast:0 row_mask:0xf bank_mask:0xf
    v_dot2c_f32_bf16_dpp v185, v189, v69 row_newbcast:0 row_mask:0xf bank_mask:0xf
    v_dot2c_f32_bf16_dpp v186, v189, v70 row_newbcast:0 row_mask:0xf bank_mask:0xf
    v_dot2c_f32_bf16_dpp v187, v189, v71 row_newbcast:0 row_mask:0xf bank_mask:0xf
    s_waitcnt vmcnt(10)
    v_perm_b32 v64, v100, v96, s80
    v_perm_b32 v65, v100, v96, s81
    v_perm_b32 v66, v101, v97, s80
    v_perm_b32 v67, v101, v97, s81
    v_perm_b32 v68, v102, v98, s80
    v_perm_b32 v69, v102, v98, s81
    v_perm_b32 v70, v103, v99, s80
    v_perm_b32 v71, v103, v99, s81
    v_dot2c_f32_bf16_dpp v180, v188, v64 row_newbcast:4 row_mask:0xf bank_mask:0xf
    v_dot2c_f32_bf16_dpp v181, v188, v65 row_newbcast:4 row_mask:0xf bank_mask:0xf
    v_dot2c_f32_bf16_dpp v182, v188, v66 row_newbcast:4 row_mask:0xf bank_mask:0xf
    v_dot2c_f32_bf16_dpp v183, v188, v67 row_newbcast:4 row_mask:0xf bank_mask:0xf
    v_dot2c_f32_bf16_dpp v184, v188, v68 row_newbcast:4 row_mask:0xf bank_mask:0xf
    v_dot2c_f32_bf16_dpp v185, v188, v69 row_newbcast:4 row_mask:0xf bank_mask:0xf
    v_dot2c_f32_bf16_dpp v186, v188, v70 row_newbcast:4 row_mask:0xf bank_mask:0xf
    v_dot2c_f32_bf16_dpp v187, v188, v71 row_newbcast:4 row_mask:0xf bank_mask:0xf
    s_waitcnt vmcnt(8)
    v_perm_b32 v64, v108, v104, s80
    v_perm_b32 v65, v108, v104, s81
    v_perm_b32 v66, v109, v105, s80
    v_perm_b32 v67, v109, v105, s81
    v_perm_b32 v68, v110, v106, s80
    v_perm_b32 v69, v110, v106, s81
    v_perm_b32 v70, v111, v107, s80
    v_perm_b32 v71, v111, v107, s81
    v_dot2c_f32_bf16_dpp v180, v189, v64 row_newbcast:4 row_mask:0xf bank_mask:0xf
    v_dot2c_f32_bf16_dpp v181, v189, v65 row_newbcast:4 row_mask:0xf bank_mask:0xf
    v_dot2c_f32_bf16_dpp v182, v189, v66 row_newbcast:4 row_mask:0xf bank_mask:0xf
    v_dot2c_f32_bf16_dpp v183, v189, v67 row_newbcast:4 row_mask:0xf bank_mask:0xf
    v_dot2c_f32_bf16_dpp v184, v189, v68 row_newbcast:4 row_mask:0xf bank_mask:0xf
    v_dot2c_f32_bf16_dpp v185, v189, v69 row_newbcast:4 row_mask:0xf bank_mask:0xf
    v_dot2c_f32_bf16_dpp v186, v189, v70 row_newbcast:4 row_mask:0xf bank_mask:0xf
    v_dot2c_f32_bf16_dpp v187, v189, v71 row_newbcast:4 row_mask:0xf bank_mask:0xf
    s_waitcnt vmcnt(6)
    v_perm_b32 v64, v116, v112, s80
    v_perm_b32 v65, v116, v112, s81
    v_perm_b32 v66, v117, v113, s80
    v_perm_b32 v67, v117, v113, s81
    v_perm_b32 v68, v118, v114, s80
    v_perm_b32 v69, v118, v114, s81
    v_perm_b32 v70, v119, v115, s80
    v_perm_b32 v71, v119, v115, s81
    v_dot2c_f32_bf16_dpp v180, v188, v64 row_newbcast:8 row_mask:0xf bank_mask:0xf
    v_dot2c_f32_bf16_dpp v181, v188, v65 row_newbcast:8 row_mask:0xf bank_mask:0xf
    v_dot2c_f32_bf16_dpp v182, v188, v66 row_newbcast:8 row_mask:0xf bank_mask:0xf
    v_dot2c_f32_bf16_dpp v183, v188, v67 row_newbcast:8 row_mask:0xf bank_mask:0xf
    v_dot2c_f32_bf16_dpp v184, v188, v68 row_newbcast:8 row_mask:0xf bank_mask:0xf
    v_dot2c_f32_bf16_dpp v185, v188, v69 row_newbcast:8 row_mask:0xf bank_mask:0xf
    v_dot2c_f32_bf16_dpp v186, v188, v70 row_newbcast:8 row_mask:0xf bank_mask:0xf
    v_dot2c_f32_bf16_dpp v187, v188, v71 row_newbcast:8 row_mask:0xf bank_mask:0xf
    s_waitcnt vmcnt(4)
    v_perm_b32 v64, v124, v120, s80
    v_perm_b32 v65, v124, v120, s81
    v_perm_b32 v66, v125, v121, s80
    v_perm_b32 v67, v125, v121, s81
    v_perm_b32 v68, v126, v122, s80
    v_perm_b32 v69, v126, v122, s81
    v_perm_b32 v70, v127, v123, s80
    v_perm_b32 v71, v127, v123, s81
    v_dot2c_f32_bf16_dpp v180, v189, v64 row_newbcast:8 row_mask:0xf bank_mask:0xf
    v_dot2c_f32_bf16_dpp v181, v189, v65 row_newbcast:8 row_mask:0xf bank_mask:0xf
    v_dot2c_f32_bf16_dpp v182, v189, v66 row_newbcast:8 row_mask:0xf bank_mask:0xf
    v_dot2c_f32_bf16_dpp v183, v189, v67 row_newbcast:8 row_mask:0xf bank_mask:0xf
    v_dot2c_f32_bf16_dpp v184, v189, v68 row_newbcast:8 row_mask:0xf bank_mask:0xf
    v_dot2c_f32_bf16_dpp v185, v189, v69 row_newbcast:8 row_mask:0xf bank_mask:0xf
    v_dot2c_f32_bf16_dpp v186, v189, v70 row_newbcast:8 row_mask:0xf bank_mask:0xf
    v_dot2c_f32_bf16_dpp v187, v189, v71 row_newbcast:8 row_mask:0xf bank_mask:0xf
    s_waitcnt vmcnt(2)
    v_perm_b32 v64, v132, v128, s80
    v_perm_b32 v65, v132, v128, s81
    v_perm_b32 v66, v133, v129, s80
    v_perm_b32 v67, v133, v129, s81
    v_perm_b32 v68, v134, v130, s80
    v_perm_b32 v69, v134, v130, s81
    v_perm_b32 v70, v135, v131, s80
    v_perm_b32 v71, v135, v131, s81
    v_dot2c_f32_bf16_dpp v180, v188, v64 row_newbcast:12 row_mask:0xf bank_mask:0xf
    v_dot2c_f32_bf16_dpp v181, v188, v65 row_newbcast:12 row_mask:0xf bank_mask:0xf
    v_dot2c_f32_bf16_dpp v182, v188, v66 row_newbcast:12 row_mask:0xf bank_mask:0xf
    v_dot2c_f32_bf16_dpp v183, v188, v67 row_newbcast:12 row_mask:0xf bank_mask:0xf
    v_dot2c_f32_bf16_dpp v184, v188, v68 row_newbcast:12 row_mask:0xf bank_mask:0xf
    v_dot2c_f32_bf16_dpp v185, v188, v69 row_newbcast:12 row_mask:0xf bank_mask:0xf
    v_dot2c_f32_bf16_dpp v186, v188, v70 row_newbcast:12 row_mask:0xf bank_mask:0xf
    v_dot2c_f32_bf16_dpp v187, v188, v71 row_newbcast:12 row_mask:0xf bank_mask:0xf
    s_waitcnt vmcnt(0)
    v_perm_b32 v64, v140, v136, s80
    v_perm_b32 v65, v140, v136, s81
    v_perm_b32 v66, v141, v137, s80
    v_perm_b32 v67, v141, v137, s81
    v_perm_b32 v68, v142, v138, s80
    v_perm_b32 v69, v142, v138, s81
    v_perm_b32 v70, v143, v139, s80
    v_perm_b32 v71, v143, v139, s81
    v_dot2c_f32_bf16_dpp v180, v189, v64 row_newbcast:12 row_mask:0xf bank_mask:0xf
    v_dot2c_f32_bf16_dpp v181, v189, v65 row_newbcast:12 row_mask:0xf bank_mask:0xf
    v_dot2c_f32_bf16_dpp v182, v189, v66 row_newbcast:12 row_mask:0xf bank_mask:0xf
    v_dot2c_f32_bf16_dpp v183, v189, v67 row_newbcast:12 row_mask:0xf bank_mask:0xf
    v_dot2c_f32_bf16_dpp v184, v189, v68 row_newbcast:12 row_mask:0xf bank_mask:0xf
    v_dot2c_f32_bf16_dpp v185, v189, v69 row_newbcast:12 row_mask:0xf bank_mask:0xf
    v_dot2c_f32_bf16_dpp v186, v189, v70 row_newbcast:12 row_mask:0xf bank_mask:0xf
    v_dot2c_f32_bf16_dpp v187, v189, v71 row_newbcast:12 row_mask:0xf bank_mask:0xf
    s_lshl_b32 s82, s3, 9
    v_and_b32 v14, 15, v0
    v_lshrrev_b32 v15, 4, v0
    v_permlane32_swap_b32 v180, v184
    v_permlane32_swap_b32 v181, v185
    v_permlane32_swap_b32 v182, v186
    v_permlane32_swap_b32 v183, v187
    v_lshlrev_b32 v15, 3, v15
    v_add_f32 v180, v180, v184
    v_add_f32 v181, v181, v185
    v_add_f32 v182, v182, v186
    v_add_f32 v183, v183, v187
    v_lshl_add_u32 v14, v14, 5, v15
    v_add_u32 v14, s82, v14
    v_permlane16_swap_b32 v180, v182
    v_permlane16_swap_b32 v181, v183
    s_nop 0
    v_add_f32 v180, v180, v182
    v_add_f32 v181, v181, v183
    ds_write_b64 v14, v[180:181] offset:6144
    v_mfma_f32_16x16x16_bf16 v[32:35], v[190:191], v[160:161], 0
    v_mfma_f32_16x16x16_bf16 v[36:39], v[190:191], v[162:163], 0
    v_mfma_f32_16x16x16_bf16 v[40:43], v[190:191], v[164:165], 0
    v_mfma_f32_16x16x16_bf16 v[44:47], v[190:191], v[166:167], 0
    v_mfma_f32_16x16x16_bf16 v[48:51], v[190:191], v[168:169], 0
    s_mul_i32 s82, s6, 40
    s_mul_i32 s83, s3, 5
    s_add_u32 s82, s82, s83
    s_lshl_b32 s82, s82, 7
    s_add_u32 s82, s82, s8
    s_lshl_b32 s82, s82, 6
    s_add_u32 s82, s82, s92
    v_lshrrev_b32 v14, 4, v0
    v_lshlrev_b32 v14, 13, v14
    v_bfe_u32 v15, v0, 2, 2
    v_lshlrev_b32 v15, 4, v15
    v_add3_u32 v60, v14, v15, s82
    s_add_u32 s82, s82, 32768
    v_add_u32 v61, s82, v15
    s_mov_b32 s84, 1249280
    v_mov_b32 v19, v32
    v_mov_b32_dpp v19, v36 quad_perm:[0,1,2,3] row_mask:0x2 bank_mask:0xf
    v_mov_b32_dpp v19, v40 quad_perm:[0,1,2,3] row_mask:0x4 bank_mask:0xf
    v_mov_b32_dpp v19, v44 quad_perm:[0,1,2,3] row_mask:0x8 bank_mask:0xf
    s_nop 1
    v_mov_b32_dpp v52, v19 quad_perm:[0,0,0,0] row_mask:0xf bank_mask:0xf
    v_mov_b32_dpp v53, v19 quad_perm:[1,1,1,1] row_mask:0xf bank_mask:0xf
    v_mov_b32_dpp v54, v19 quad_perm:[2,2,2,2] row_mask:0xf bank_mask:0xf
    v_mov_b32_dpp v55, v19 quad_perm:[3,3,3,3] row_mask:0xf bank_mask:0xf
    v_mov_b32_dpp v56, v48 quad_perm:[0,0,0,0] row_mask:0xf bank_mask:0xf
    v_mov_b32_dpp v57, v48 quad_perm:[1,1,1,1] row_mask:0xf bank_mask:0xf
    v_mov_b32_dpp v58, v48 quad_perm:[2,2,2,2] row_mask:0xf bank_mask:0xf
    v_mov_b32_dpp v59, v48 quad_perm:[3,3,3,3] row_mask:0xf bank_mask:0xf
    v_perm_b32 v52, v52, v13, s76
    v_perm_b32 v53, v53, v13, s77
    v_perm_b32 v54, v54, v13, s78
    v_perm_b32 v55, v55, v13, s79
    v_perm_b32 v56, v56, v13, s76
    v_perm_b32 v57, v57, v13, s77
    v_perm_b32 v58, v58, v13, s78
    v_perm_b32 v59, v59, v13, s79
    s_mov_b32 exec_lo, 0x11111111
    s_mov_b32 exec_hi, 0x11111111
    buffer_store_dwordx4 v[52:55], v60, s[64:67], s84 offen sc1
    s_mov_b32 exec_lo, 0x1111
    s_mov_b32 exec_hi, 0
    buffer_store_dwordx4 v[56:59], v61, s[64:67], s84 offen sc1
    s_mov_b64 exec, -1
L_J4:
    s_mul_i32 s86, s4, 4608
    v_lshrrev_b32 v14, 5, v0
    v_mul_u32_u24 v14, 576, v14
    v_and_b32 v15, 31, v0
    v_lshl_add_u32 v14, v15, 4, v14
    v_add_u32 v224, s86, v14
    v_and_b32 v14, 7, v0
    v_mul_u32_u24 v14, 576, v14
    s_add_u32 s87, s86, 512
    v_add_u32 v225, s87, v14
    s_mov_b32 s88, 790528
    s_mov_b32 s89, 937984
    s_waitcnt lgkmcnt(0)
    s_barrier
    s_cmp_eq_u32 s3, 0
    s_cbranch_scc0 L_nocomb
    v_and_b32 v15, 31, v0
    v_lshlrev_b32 v15, 4, v15
    v_mov_b32 v14, 0
    ds_read_b128 v[112:115], v14 offset:11552
    ds_read_b128 v[116:119], v14 offset:11568
    ds_read_b128 v[80:83], v15 offset:6144
    ds_read_b128 v[84:87], v15 offset:6656
    ds_read_b128 v[88:91], v15 offset:7168
    ds_read_b128 v[92:95], v15 offset:7680
    ds_read_b128 v[96:99], v15 offset:8192
    ds_read_b128 v[100:103], v15 offset:8704
    ds_read_b128 v[104:107], v15 offset:9216
    ds_read_b128 v[108:111], v15 offset:9728
    ds_read_b128 v[120:123], v14 offset:11584
    ds_read_b128 v[124:127], v14 offset:11600
    s_mul_i32 s82, s5, 576
    s_add_u32 s82, s82, s86
    v_lshl_add_u32 v128, v0, 4, s82
    s_waitcnt lgkmcnt(10)
    v_max3_f32 v129, v112, v113, v114
    v_max3_f32 v129, v129, v115, v116
    v_max3_f32 v129, v129, v117, v118
    v_max_f32 v129, v129, v119
    v_sub_f32 v112, v112, v129
    v_sub_f32 v113, v113, v129
    v_sub_f32 v114, v114, v129
    v_sub_f32 v115, v115, v129
    v_sub_f32 v116, v116, v129
    v_sub_f32 v117, v117, v129
    v_sub_f32 v118, v118, v129
    v_sub_f32 v119, v119, v129
    v_exp_f32 v112, v112
    v_exp_f32 v113, v113
    v_exp_f32 v114, v114
    v_exp_f32 v115, v115
    v_exp_f32 v116, v116
    v_exp_f32 v117, v117
    v_exp_f32 v118, v118
    v_exp_f32 v119, v119
    s_waitcnt lgkmcnt(2)
    v_mul_f32 v80, v80, v112
    v_mul_f32 v81, v81, v112
    v_mul_f32 v82, v82, v112
    v_mul_f32 v83, v83, v112
    v_fmac_f32 v80, v84, v113
    v_fmac_f32 v81, v85, v113
    v_fmac_f32 v82, v86, v113
    v_fmac_f32 v83, v87, v113
    v_fmac_f32 v80, v88, v114
    v_fmac_f32 v81, v89, v114
    v_fmac_f32 v82, v90, v114
    v_fmac_f32 v83, v91, v114
    v_fmac_f32 v80, v92, v115
    v_fmac_f32 v81, v93, v115
    v_fmac_f32 v82, v94, v115
    v_fmac_f32 v83, v95, v115
    v_fmac_f32 v80, v96, v116
    v_fmac_f32 v81, v97, v116
    v_fmac_f32 v82, v98, v116
    v_fmac_f32 v83, v99, v116
    v_fmac_f32 v80, v100, v117
    v_fmac_f32 v81, v101, v117
    v_fmac_f32 v82, v102, v117
    v_fmac_f32 v83, v103, v117
    v_fmac_f32 v80, v104, v118
    v_fmac_f32 v81, v105, v118
    v_fmac_f32 v82, v106, v118
    v_fmac_f32 v83, v107, v118
    v_fmac_f32 v80, v108, v119
    v_fmac_f32 v81, v109, v119
    v_fmac_f32 v82, v110, v119
    v_fmac_f32 v83, v111, v119
    s_waitcnt lgkmcnt(0)
    v_mul_f32 v130, v112, v120
    v_fmac_f32 v130, v113, v121
    v_fmac_f32 v130, v114, v122
    v_fmac_f32 v130, v115, v123
    v_fmac_f32 v130, v116, v124
    v_fmac_f32 v130, v117, v125
    v_fmac_f32 v130, v118, v126
    v_fmac_f32 v130, v119, v127
    v_perm_b32 v80, v80, v13, s76
    v_perm_b32 v81, v81, v13, s77
    v_perm_b32 v82, v82, v13, s78
    v_perm_b32 v83, v83, v13, s79
    s_mov_b32 exec_lo, 0
    s_mov_b32 exec_hi, 1
    v_mov_b32 v80, v129
    v_mov_b32 v81, v130
    v_mov_b32 v82, v13
    v_mov_b32 v83, v13
    s_mov_b32 exec_lo, -1
    s_nop 0
    buffer_store_dwordx4 v[80:83], v128, s[64:67], s88 offen
    buffer_store_dwordx4 v[80:83], v128, s[64:67], s89 offen sc1
    s_mov_b64 exec, -1
L_nocomb:
    s_cmp_eq_u32 s3, 1
    s_cbranch_scc0 L_nogath
    v_bfe_u32 v14, v0, 2, 1
    v_lshlrev_b32 v14, 2, v14
    ds_read_b32 v108, v14 offset:11616
    s_mov_b32 s94, 0
L_opoll:
    s_add_u32 s94, s94, 1
    s_and_b32 s90, s94, 7
    s_cmp_eq_u32 s90, 0
    s_cselect_b32 s90, s89, s88
    buffer_load_dwordx4 v[80:83], v224, s[64:67], s90 offen offset:0 sc1
    buffer_load_dwordx4 v[84:87], v224, s[64:67], s90 offen offset:1152 sc1
    buffer_load_dwordx4 v[88:91], v224, s[64:67], s90 offen offset:2304 sc1
    buffer_load_dwordx4 v[92:95], v224, s[64:67], s90 offen offset:3456 sc1
    buffer_load_dwordx4 v[96:99], v225, s[64:67], s90 offen sc1
    s_waitcnt vmcnt(0)
    v_perm_b32 v14, v81, v80, s98
    v_perm_b32 v15, v83, v82, s98
    v_perm_b32 v14, v15, v14, s99
    v_cmp_ne_u32 vcc, v14, v13
    v_perm_b32 v14, v85, v84, s98
    v_perm_b32 v15, v87, v86, s98
    v_perm_b32 v14, v15, v14, s99
    v_cmp_ne_u32 s[12:13], v14, v13
    s_nop 0
    s_or_b64 vcc, vcc, s[12:13]
    v_perm_b32 v14, v89, v88, s98
    v_perm_b32 v15, v91, v90, s98
    v_perm_b32 v14, v15, v14, s99
    v_cmp_ne_u32 s[12:13], v14, v13
    s_nop 0
    s_or_b64 vcc, vcc, s[12:13]
    v_perm_b32 v14, v93, v92, s98
    v_perm_b32 v15, v95, v94, s98
    v_perm_b32 v14, v15, v14, s99
    v_cmp_ne_u32 s[12:13], v14, v13
    s_nop 0
    s_or_b64 vcc, vcc, s[12:13]
    v_cmp_ne_u32 s[12:13], v98, v13
    s_nop 0
    s_or_b64 vcc, vcc, s[12:13]
    s_nop 0
    s_cbranch_vccz L_ook
    s_cmp_gt_u32 s94, 40000
    s_sleep 1
    s_cbranch_scc0 L_opoll
L_ook:
    v_mov_b32 v100, v96
    s_nop 0
    v_max_f32_dpp v100, v100, v100 quad_perm:[1,0,3,2] row_mask:0xf bank_mask:0xf
    s_nop 1
    v_max_f32_dpp v100, v100, v100 quad_perm:[2,3,0,1] row_mask:0xf bank_mask:0xf
    s_nop 1
    v_sub_f32 v96, v96, v100
    v_exp_f32 v96, v96
    v_and_b32 v80, 0xffffff00, v80
    v_and_b32 v81, 0xffffff00, v81
    v_and_b32 v82, 0xffffff00, v82
    v_and_b32 v83, 0xffffff00, v83
    v_and_b32 v84, 0xffffff00, v84
    v_and_b32 v85, 0xffffff00, v85
    v_and_b32 v86, 0xffffff00, v86
    v_and_b32 v87, 0xffffff00, v87
    v_and_b32 v88, 0xffffff00, v88
    v_and_b32 v89, 0xffffff00, v89
    v_and_b32 v90, 0xffffff00, v90
    v_and_b32 v91, 0xffffff00, v91
    v_and_b32 v92, 0xffffff00, v92
    v_and_b32 v93, 0xffffff00, v93
    v_and_b32 v94, 0xffffff00, v94
    v_and_b32 v95, 0xffffff00, v95
    v_mul_f32 v97, v97, v96
    s_nop 1
    v_add_f32_dpp v97, v97, v97 quad_perm:[1,0,3,2] row_mask:0xf bank_mask:0xf
    s_nop 1
    v_add_f32_dpp v97, v97, v97 quad_perm:[2,3,0,1] row_mask:0xf bank_mask:0xf
    s_nop 1
    v_rcp_f32 v97, v97
    s_waitcnt lgkmcnt(0)
    v_mul_f32 v96, v96, v108
    v_mul_f32 v96, v96, v97
    s_nop 1
    v_mov_b32_dpp v100, v96 row_newbcast:0 row_mask:0x3 bank_mask:0xf
    v_mov_b32_dpp v100, v96 row_newbcast:1 row_mask:0xc bank_mask:0xf
    v_mov_b32_dpp v101, v96 row_newbcast:2 row_mask:0x3 bank_mask:0xf
    v_mov_b32_dpp v101, v96 row_newbcast:3 row_mask:0xc bank_mask:0xf
    v_mov_b32_dpp v102, v96 row_newbcast:4 row_mask:0x3 bank_mask:0xf
    v_mov_b32_dpp v102, v96 row_newbcast:5 row_mask:0xc bank_mask:0xf
    v_mov_b32_dpp v103, v96 row_newbcast:6 row_mask:0x3 bank_mask:0xf
    v_mov_b32_dpp v103, v96 row_newbcast:7 row_mask:0xc bank_mask:0xf
    v_mul_f32 v80, v80, v100
    v_mul_f32 v81, v81, v100
    v_mul_f32 v82, v82, v100
    v_mul_f32 v83, v83, v100
    v_mul_f32 v88, v88, v102
    v_mul_f32 v89, v89, v102
    v_mul_f32 v90, v90, v102
    v_mul_f32 v91, v91, v102
    v_fmac_f32 v80, v84, v101
    v_fmac_f32 v81, v85, v101
    v_fmac_f32 v82, v86, v101
    v_fmac_f32 v83, v87, v101
    v_fmac_f32 v88, v92, v103
    v_fmac_f32 v89, v93, v103
    v_fmac_f32 v90, v94, v103
    v_fmac_f32 v91, v95, v103
    v_bfe_u32 v14, v0, 3, 2
    v_lshlrev_b32 v14, 6, v14
    v_permlane32_swap_b32 v80, v88
    v_permlane32_swap_b32 v81, v89
    v_permlane32_swap_b32 v82, v90
    v_permlane32_swap_b32 v83, v91
    v_and_b32 v15, 3, v0
    v_lshl_add_u32 v14, v15, 4, v14
    v_bfe_u32 v15, v0, 2, 1
    v_lshl_add_u32 v14, v15, 3, v14
    v_add_f32 v80, v80, v88
    v_add_f32 v81, v81, v89
    v_add_f32 v82, v82, v90
    v_add_f32 v83, v83, v91
    v_lshrrev_b32 v15, 5, v0
    v_mul_u32_u24 v15, 272, v15
    v_add_u32 v14, v14, v15
    v_cvt_pk_bf16_f32 v80, v80, v81
    v_cvt_pk_bf16_f32 v81, v82, v83
    ds_write_b64 v14, v[80:81] offset:10240
L_nogath:
    v_and_b32 v14, 15, v0
    v_min_u32 v14, 2, v14
    v_mul_u32_u24 v14, 272, v14
    v_lshrrev_b32 v15, 4, v0
    v_lshl_add_u32 v132, v15, 4, v14
    s_mul_i32 s82, s5, 5
    s_add_u32 s82, s82, s3
    s_lshl_b32 s82, s82, 5
    s_add_u32 s82, s82, s4
    s_lshl_b32 s82, s82, 6
    v_bfe_u32 v15, v0, 2, 2
    v_lshl_add_u32 v133, v15, 4, s82
    s_mov_b32 s84, 1085440
    s_mov_b32 s85, 1167360
    s_waitcnt lgkmcnt(0)
    s_barrier
    s_cmp_ge_u32 s3, 5
    s_cbranch_scc1 L_noproj
    ds_read_b128 v[64:67], v132 offset:10240
    ds_read_b128 v[68:71], v132 offset:10304
    ds_read_b128 v[72:75], v132 offset:10368
    ds_read_b128 v[76:79], v132 offset:10432
    s_waitcnt lgkmcnt(3)
    v_mfma_f32_16x16x32_bf16 v[32:35], v[64:67], v[144:147], 0
    s_waitcnt lgkmcnt(2)
    v_mfma_f32_16x16x32_bf16 v[32:35], v[68:71], v[148:151], v[32:35]
    s_waitcnt lgkmcnt(1)
    v_mfma_f32_16x16x32_bf16 v[32:35], v[72:75], v[152:155], v[32:35]
    s_waitcnt lgkmcnt(0)
    v_mfma_f32_16x16x32_bf16 v[32:35], v[76:79], v[156:159], v[32:35]
    s_nop 7
    v_mov_b32_dpp v52, v32 quad_perm:[0,0,0,0] row_mask:0xf bank_mask:0xf
    v_mov_b32_dpp v53, v32 quad_perm:[1,1,1,1] row_mask:0xf bank_mask:0xf
    v_mov_b32_dpp v54, v32 quad_perm:[2,2,2,2] row_mask:0xf bank_mask:0xf
    v_mov_b32_dpp v55, v32 quad_perm:[3,3,3,3] row_mask:0xf bank_mask:0xf
    v_mov_b32_dpp v56, v33 quad_perm:[0,0,0,0] row_mask:0xf bank_mask:0xf
    v_mov_b32_dpp v57, v33 quad_perm:[1,1,1,1] row_mask:0xf bank_mask:0xf
    v_mov_b32_dpp v58, v33 quad_perm:[2,2,2,2] row_mask:0xf bank_mask:0xf
    v_mov_b32_dpp v59, v33 quad_perm:[3,3,3,3] row_mask:0xf bank_mask:0xf
    v_perm_b32 v52, v52, v13, s76
    v_perm_b32 v53, v53, v13, s77
    v_perm_b32 v54, v54, v13, s78
    v_perm_b32 v55, v55, v13, s79
    v_perm_b32 v56, v56, v13, s76
    v_perm_b32 v57, v57, v13, s77
    v_perm_b32 v58, v58, v13, s78
    v_perm_b32 v59, v59, v13, s79
    s_mov_b32 exec_lo, 0x1111
    s_mov_b32 exec_hi, 0
    buffer_store_dwordx4 v[52:55], v133, s[64:67], s84 offen sc1
    buffer_store_dwordx4 v[56:59], v133, s[64:67], s85 offen sc1
    s_mov_b64 exec, -1
L_noproj:
    s_cmp_eq_u32 s93, 0
    s_cbranch_scc1 L_fin
    s_and_b32 s82, s2, 127
    s_mul_i32 s83, s6, 40
    s_add_u32 s83, s83, s82
    s_lshl_b32 s84, s3, 10
    s_lshl_b32 s85, s83, 13
    s_add_u32 s85, s85, s84
    v_lshl_add_u32 v76, v0, 4, s85
    s_lshl_b32 s85, s83, 11
    s_add_u32 s85, s85, s84
    v_lshl_add_u32 v77, v0, 4, s85
    s_mov_b32 s86, 1085440
    s_mov_b32 s87, 1249280
    s_lshl_b32 s88, s3, 4
    v_lshrrev_b32 v14, 2, v0
    v_add_u32 v14, s88, v14
    s_movk_i32 s89, 108
    v_cmp_gt_u32 s[14:15], s89, v14
    s_lshl_b32 s82, s6, 2
    v_mov_b32 v14, s82
    ds_read_b32 v78, v14 offset:11616
    v_and_b32 v14, 3, v0
    v_lshrrev_b32 v15, 4, v0
    v_lshl_add_u32 v14, v14, 2, v15
    s_lshl_b32 s82, s3, 2
    v_lshl_add_u32 v79, v14, 5, s82
    s_mov_b32 s94, 0
L_rpoll1:
    buffer_load_dwordx4 v[68:71], v76, s[64:67], s87 offen sc1
    s_waitcnt vmcnt(0)
    v_perm_b32 v14, v69, v68, s98
    v_perm_b32 v15, v71, v70, s98
    v_perm_b32 v14, v15, v14, s99
    v_cmp_ne_u32 vcc, v14, v13
    s_nop 0
    s_and_b64 vcc, vcc, s[14:15]
    s_nop 0
    s_cbranch_vccz L_rok1
    s_add_u32 s94, s94, 1
    s_cmp_gt_u32 s94, 20000
    s_cbranch_scc1 L_rok1
    s_sleep 1
    s_branch L_rpoll1
L_rok1:
    v_and_b32 v68, 0xffffff00, v68
    v_and_b32 v69, 0xffffff00, v69
    v_and_b32 v70, 0xffffff00, v70
    v_and_b32 v71, 0xffffff00, v71
    v_cndmask_b32 v68, 0, v68, s[14:15]
    v_cndmask_b32 v69, 0, v69, s[14:15]
    v_cndmask_b32 v70, 0, v70, s[14:15]
    v_cndmask_b32 v71, 0, v71, s[14:15]
    s_waitcnt lgkmcnt(0)
    v_sub_f32 v78, 1.0, v78
    v_mul_f32 v68, v78, v68
    v_mul_f32 v69, v78, v69
    v_mul_f32 v70, v78, v70
    v_mul_f32 v71, v78, v71
    s_nop 0
    v_add_f32_dpp v68, v68, v68 row_ror:4 row_mask:0xf bank_mask:0xf
    v_add_f32_dpp v69, v69, v69 row_ror:4 row_mask:0xf bank_mask:0xf
    v_add_f32_dpp v70, v70, v70 row_ror:4 row_mask:0xf bank_mask:0xf
    v_add_f32_dpp v71, v71, v71 row_ror:4 row_mask:0xf bank_mask:0xf
    v_add_f32_dpp v68, v68, v68 row_ror:8 row_mask:0xf bank_mask:0xf
    v_add_f32_dpp v69, v69, v69 row_ror:8 row_mask:0xf bank_mask:0xf
    v_add_f32_dpp v70, v70, v70 row_ror:8 row_mask:0xf bank_mask:0xf
    v_add_f32_dpp v71, v71, v71 row_ror:8 row_mask:0xf bank_mask:0xf
    s_nop 0
    v_permlane32_swap_b32 v68, v70
    v_permlane32_swap_b32 v69, v71
    s_nop 0
    v_add_f32 v68, v68, v70
    v_add_f32 v69, v69, v71
    s_nop 1
    v_permlane16_swap_b32 v68, v69
    s_nop 0
    v_add_f32 v68, v68, v69
    ds_write_b32 v79, v68 offset:11664
    s_waitcnt lgkmcnt(0)
    s_barrier
    s_cmp_eq_u32 s3, 0
    s_cbranch_scc0 L_fin
    buffer_load_dwordx4 v[64:67], v77, s[64:67], s86 offen sc1
    buffer_load_dwordx4 v[72:75], v77, s[64:67], s86 offen offset:1024 sc1
    ds_read_b128 v[80:83], v79 offset:11664
    ds_read_b128 v[84:87], v79 offset:11680
    s_and_b32 s82, s2, 127
    s_lshl_b32 s82, s82, 5
    s_mul_i32 s83, s6, 1280
    s_add_u32 s82, s82, s83
    v_lshrrev_b32 v88, 4, v79
    v_add_u32 v88, s82, v88
    s_waitcnt lgkmcnt(0)
    v_add_f32 v80, v80, v84
    v_add_f32 v81, v81, v85
    v_add_f32 v82, v82, v86
    v_add_f32 v83, v83, v87
    v_add_f32 v80, v80, v81
    v_add_f32 v82, v82, v83
    v_add_f32 v80, v80, v82
    s_mov_b32 s94, 0
    s_branch L_rchk2
L_rpoll2:
    buffer_load_dwordx4 v[64:67], v77, s[64:67], s86 offen sc1
    buffer_load_dwordx4 v[72:75], v77, s[64:67], s86 offen offset:1024 sc1
L_rchk2:
    s_waitcnt vmcnt(0)
    v_perm_b32 v14, v65, v64, s98
    v_perm_b32 v15, v67, v66, s98
    v_perm_b32 v14, v15, v14, s99
    v_cmp_ne_u32 vcc, v14, v13
    v_perm_b32 v14, v73, v72, s98
    v_perm_b32 v15, v75, v74, s98
    v_perm_b32 v14, v15, v14, s99
    v_cmp_ne_u32 s[12:13], v14, v13
    s_nop 0
    s_or_b64 vcc, vcc, s[12:13]
    s_nop 0
    s_cbranch_vccz L_rgot
    s_add_u32 s94, s94, 1
    s_cmp_gt_u32 s94, 40000
    s_cbranch_scc1 L_rgot
    s_sleep 1
    s_branch L_rpoll2
L_rgot:
    v_and_b32 v64, 0xffffff00, v64
    v_and_b32 v65, 0xffffff00, v65
    v_and_b32 v66, 0xffffff00, v66
    v_and_b32 v67, 0xffffff00, v67
    v_and_b32 v72, 0xffffff00, v72
    v_and_b32 v73, 0xffffff00, v73
    v_and_b32 v74, 0xffffff00, v74
    v_and_b32 v75, 0xffffff00, v75
    v_add_f32 v64, v64, v72
    v_add_f32 v65, v65, v73
    v_add_f32 v66, v66, v74
    v_add_f32 v67, v67, v75
    s_nop 0
    v_add_f32_dpp v64, v64, v64 row_ror:4 row_mask:0xf bank_mask:0xf
    v_add_f32_dpp v65, v65, v65 row_ror:4 row_mask:0xf bank_mask:0xf
    v_add_f32_dpp v66, v66, v66 row_ror:4 row_mask:0xf bank_mask:0xf
    v_add_f32_dpp v67, v67, v67 row_ror:4 row_mask:0xf bank_mask:0xf
    v_add_f32_dpp v64, v64, v64 row_ror:8 row_mask:0xf bank_mask:0xf
    v_add_f32_dpp v65, v65, v65 row_ror:8 row_mask:0xf bank_mask:0xf
    v_add_f32_dpp v66, v66, v66 row_ror:8 row_mask:0xf bank_mask:0xf
    v_add_f32_dpp v67, v67, v67 row_ror:8 row_mask:0xf bank_mask:0xf
    s_nop 0
    v_permlane32_swap_b32 v64, v66
    v_permlane32_swap_b32 v65, v67
    s_nop 0
    v_add_f32 v64, v64, v66
    v_add_f32 v65, v65, v67
    s_nop 1
    v_permlane16_swap_b32 v64, v65
    s_nop 0
    v_add_f32 v64, v64, v65
    v_add_f32 v64, v64, v80
    v_cvt_pk_bf16_f32 v64, v64, v64
    s_mov_b32 exec_lo, 0x000f000f
    s_mov_b32 exec_hi, 0x000f000f
    buffer_store_short v64, v88, s[68:71], 0 offen
    s_cmp_eq_u32 s2, 0
    s_cbranch_scc0 L_noepoch
    s_mov_b32 exec_lo, 1
    s_mov_b32 exec_hi, 0
    v_mov_b32 v14, 0
    buffer_store_dword v13, v14, s[64:67], 0 offen
L_noepoch:
    s_mov_b64 exec, -1
L_fin:
L_end:
    s_endpgm
.section .rodata,"a"
.p2align 6
.amdhsa_kernel gated_mix__sliding_block_cached__dense_activation_silu__decode_kernel
  .amdhsa_next_free_vgpr 256
  .amdhsa_next_free_sgpr 102
  .amdhsa_accum_offset 256
  .amdhsa_group_segment_fixed_size 0
  .amdhsa_kernarg_size 96
  .amdhsa_user_sgpr_count 2
  .amdhsa_user_sgpr_kernarg_segment_ptr 1
  .amdhsa_system_sgpr_workgroup_id_x 1
  .amdhsa_float_denorm_mode_32 3
.end_amdhsa_kernel
```
